```python
import torch

def _softmax(x, axis=-1):
    return torch.softmax(x, dim=axis)
def _gelu(x):
    return torch.nn.functional.gelu(x, approximate="tanh")
def _silu(x):
    return torch.nn.functional.silu(x)
def _sigmoid(x):
    return torch.sigmoid(x)
def _layernorm(x, axis=-1, eps=1e-5):
    m = x.mean(dim=axis, keepdim=True)
    v = x.var(dim=axis, keepdim=True, unbiased=False)
    return (x - m) / torch.sqrt(v + eps)
def _scatter_add(tgt, idx, src, axis=0):
    return tgt.clone().index_add_(axis, idx, src)
def _segment_sum(src, seg, n):
    out = torch.zeros((n,) + src.shape[1:], dtype=src.dtype)
    return out.index_add_(0, seg, src)
def _pad(x, pw):
    flat = tuple(v for pair in reversed(pw) for v in pair)
    return torch.nn.functional.pad(x, flat)

kernel_name = 'gated_mix__ssm_conv_s4__glu_gated_bilinear__prompt'

def setup_inputs():

    _w = (lambda a: (lambda t: t.to(torch.bfloat16) if t.is_floating_point() else t)(torch.as_tensor(a)))
    def _A_setup():
        B, L, D, N = 1, 2048, 448, 256
        A_re = -(lambda _x: torch.exp(torch.as_tensor(_x)))((lambda *s: torch.randn(*s, dtype=torch.bfloat16) * 3.2)(D, N))
        A_im = torch.pi * (lambda *s: torch.randn(*s, dtype=torch.bfloat16) * 0.05)(D, N)
        B_re = (lambda *s: torch.randn(*s, dtype=torch.bfloat16) * 0.05)(D, N)
        B_im = (lambda *s: torch.randn(*s, dtype=torch.bfloat16) * 0.05)(D, N)
        C_re = (lambda *s: torch.randn(*s, dtype=torch.bfloat16) * 0.05)(D, N)
        C_im = (lambda *s: torch.randn(*s, dtype=torch.bfloat16) * 0.1)(D, N)
        log_dt = (lambda *s: torch.randn(*s, dtype=torch.bfloat16) * 0.05)(D) * 0.5 - 4.0
        Dskip = (lambda *s: torch.randn(*s, dtype=torch.bfloat16) * 0.05)(D)
        return {
            "u": _w((lambda *s: torch.randn(*s, dtype=torch.bfloat16) * 0.05)(B, L, D)),
            "A_re": _w(A_re),
            "A_im": _w(A_im),
            "B_re": _w(B_re),
            "B_im": _w(B_im),
            "C_re": _w(C_re),
            "C_im": _w(C_im),
            "log_dt": _w(log_dt),
            "Dskip": _w(Dskip),
        }
    _A_in = _A_setup()

    def _B_setup():
        B, S, D, F = 1, 2048, 448, 1792
        return {
            "x": _w((lambda *s: torch.randn(*s, dtype=torch.bfloat16) * 0.05)(B, S, D)),
            "w_gate": _w((lambda *s: torch.randn(*s, dtype=torch.bfloat16) * 0.8)(D, F) * (D ** -0.5)),
            "w_up": _w((lambda *s: torch.randn(*s, dtype=torch.bfloat16) * 0.8)(D, F) * (D ** -0.5)),
            "w_down": _w((lambda *s: torch.randn(*s, dtype=torch.bfloat16) * 0.8)(F, D) * (F ** -0.5)),
        }
    _B_in = _B_setup()

    return {
        "A_u": _A_in["u"],
        "A_A_re": _A_in["A_re"],
        "A_A_im": _A_in["A_im"],
        "A_B_re": _A_in["B_re"],
        "A_B_im": _A_in["B_im"],
        "A_C_re": _A_in["C_re"],
        "A_C_im": _A_in["C_im"],
        "A_log_dt": _A_in["log_dt"],
        "A_Dskip": _A_in["Dskip"],
        "B_x": _B_in["x"],
        "B_w_gate": _B_in["w_gate"],
        "B_w_up": _B_in["w_up"],
        "B_w_down": _B_in["w_down"],
        "gate_w": _w((lambda *s: torch.randn(*s, dtype=torch.bfloat16) * 0.05)(448) * 16.0),
    }

def reference(A_u, A_A_re, A_A_im, A_B_re, A_B_im, A_C_re, A_C_im, A_log_dt, A_Dskip, B_x, B_w_gate, B_w_up, B_w_down, gate_w):
    def _A_ref(u, A_re, A_im, B_re, B_im, C_re, C_im, log_dt, Dskip):
        Bsz, L, D = u.shape
        dt = torch.exp(log_dt)[:, None]
        A = A_re + 1j * A_im
        Bc = B_re + 1j * B_im
        Cc = C_re + 1j * C_im
        logdA = dt * A
        dB = dt * Bc
        l = (lambda x, dt: x.to(dt))(torch.arange(L), A_re.dtype)
        P = torch.exp(logdA[:, :, None] * l[None, None, :])
        K = torch.einsum("dn,dnl,dn->dl", Cc, P, dB).real
        L2 = 2 * L
        Kp = _pad(K, ((0, 0), (0, L)))
        up = (lambda x, *d: x.permute(*d))(u, 0, 2, 1)
        up = _pad(up, ((0, 0), (0, 0), (0, L)))
        Kf = (lambda x, axes=(-2,-1): torch.fft.rfft2(x.float(), dim=axes))(Kp[:, None, :], axes=(-2, -1))
        Uf = (lambda x, axes=(-2,-1): torch.fft.rfft2(x.float(), dim=axes))(up[:, :, None, :], axes=(-2, -1))
        Yf = Uf * Kf[None, :, :, :]
        y = (lambda x, s, axes=(-2,-1): torch.fft.irfft2(x, s=s, dim=axes).to(torch.bfloat16))(Yf, (1, L2), axes=(-2, -1))[:, :, 0, :L]
        y = (lambda x, *d: x.permute(*d))(y, 0, 2, 1) + u * Dskip[None, None, :]
        return y

    def _B_ref(x, w_gate, w_up, w_down):
        g = torch.einsum("bsd,df->bsf", x, w_gate)
        u = torch.einsum("bsd,df->bsf", x, w_up)
        h = g * u
        return torch.einsum("bsf,fd->bsd", h, w_down)

    x = A_u
    g = _sigmoid((x * gate_w).sum(-1, keepdims=True))
    a = _A_ref(x, A_A_re, A_A_im, A_B_re, A_B_im, A_C_re, A_C_im, A_log_dt, A_Dskip)
    b = _B_ref(x, B_w_gate, B_w_up, B_w_down)
    return g * a + (1 - g) * b
```

```asm
; @launch grid=(480,1,1) block=(256,1,1) lds=81920
.amdgcn_target "amdgcn-amd-amdhsa--gfx950"
.text
.globl gated_mix__ssm_conv_s4__glu_gated_bilinear__prompt_kernel
.p2align 8
.type gated_mix__ssm_conv_s4__glu_gated_bilinear__prompt_kernel,@function
gated_mix__ssm_conv_s4__glu_gated_bilinear__prompt_kernel:
    s_cmp_ge_u32 s2, 480
    s_cbranch_scc1 f_exit
    v_lshrrev_b32 v1, 6, v0
    v_and_b32 v0, 63, v0
    v_readfirstlane_b32 s4, v1
    s_nop 3
    s_cmp_lg_u32 s2, 0
    s_cbranch_scc1 pub_skip
    s_cmp_lg_u32 s4, 0
    s_cbranch_scc1 pub_skip
    s_load_dwordx2 s[44:45], s[0:1], 120
    s_memrealtime s[46:47]
    s_waitcnt lgkmcnt(0)
    s_or_b32 s46, s46, 1
    v_mov_b32 v22, s46
    v_mov_b32 v21, 0
    s_mov_b64 exec, 1
    global_store_dword v21, v22, s[44:45] sc1
    s_mov_b64 exec, -1
pub_skip:
    s_cmp_lt_u32 s2, 224
    s_cbranch_scc1 f_side
    s_sub_u32 s3, s2, 224
    s_and_b32 s40, s3, 7
    s_lshr_b32 s41, s3, 3
    s_sub_u32 s44, s41, 4
    s_cmp_ge_u32 s41, 8
    s_cselect_b32 s45, s44, 28
    s_cmp_lt_u32 s41, 4
    s_cselect_b32 s45, s41, s45
    s_lshl_b32 s3, s45, 3
    s_add_u32 s3, s3, s40
    s_cmp_lt_u32 s41, 4
    s_cbranch_scc1 f_aux
    s_mul_i32 s46, s44, 37
    s_lshr_b32 s46, s46, 8
    s_mul_i32 s47, s46, 7
    s_sub_u32 s47, s44, s47
    s_lshr_b32 s48, s40, 1
    s_lshl_b32 s48, s48, 2
    s_add_u32 s48, s48, s46
    s_and_b32 s49, s40, 1
    s_mul_i32 s49, s49, 7
    s_add_u32 s49, s49, s47
    s_add_u32 s50, s48, s49
    s_lshr_b32 s51, s40, 1
    s_mul_i32 s51, s51, 2
    s_add_u32 s50, s50, s51
    s_mul_i32 s51, s50, 43
    s_lshr_b32 s51, s51, 8
    s_mul_i32 s51, s51, 6
    s_sub_u32 s50, s50, s51
    s_load_dwordx2 s[28:29], s[0:1], 0
    s_load_dwordx4 s[32:35], s[0:1], 80
    s_load_dwordx2 s[30:31], s[0:1], 128
    s_lshl_b32 s5, s48, 7
    s_lshl_b32 s6, s49, 7
    v_lshrrev_b32 v10, 4, v0
    v_and_b32 v11, 15, v0
    v_lshlrev_b32 v12, 1, v10
    v_xor_b32 v11, v11, v12
    s_lshr_b32 s24, s4, 1
    s_lshl_b32 s25, s24, 3
    v_xor_b32 v11, s25, v11
    v_lshlrev_b32 v11, 4, v11
    v_mul_u32_u24 v12, 3584, v10
    v_add_u32 v2, v11, v12
    v_lshrrev_b32 v11, 3, v0
    v_mul_u32_u24 v11, 896, v11
    v_and_b32 v12, 7, v0
    v_xor_b32 v13, v12, v10
    v_lshlrev_b32 v13, 4, v13
    v_add_u32 v3, v11, v13
    v_xor_b32 v13, 64, v13
    v_add_u32 v4, v11, v13
    v_add_u32 v72, 0, v2
    v_add_u32 v76, 0, v3
    v_add_u32 v73, 13312, v2
    v_add_u32 v77, 6144, v4
    v_add_u32 v74, 26624, v2
    v_add_u32 v78, 12288, v3
    v_add_u32 v75, 39936, v2
    v_add_u32 v79, 18432, v4
    s_lshl_b32 s25, s4, 5
    s_add_u32 s20, s5, s25
    s_mul_i32 s20, s20, 896
    s_add_u32 s26, s20, 896
    s_lshl_b32 s25, s50, 7
    s_add_u32 s58, s20, s25
    s_add_u32 s58, s58, 128
    s_lshl_b32 s22, s4, 12
    s_add_u32 s22, s22, 49152
    s_and_b32 s25, s4, 1
    s_mul_i32 s21, s25, 57344
    s_lshl_b32 s23, s6, 1
    s_add_u32 s21, s21, s23
    s_add_u32 s27, s21, 1605632
    s_mul_i32 s23, s50, 229376
    s_add_u32 s59, s21, s23
    s_add_u32 s59, s59, 229376
    s_lshl_b32 s23, s24, 13
    s_lshl_b32 s25, s25, 12
    s_add_u32 s23, s23, s25
    s_waitcnt lgkmcnt(0)
    s_mov_b32 s8, s28
    s_mov_b32 s9, s29
    s_mov_b32 s10, 1835008
    s_mov_b32 s11, 0x20000
    s_cmp_eq_u32 s24, 0
    s_cselect_b32 s12, s32, s34
    s_cselect_b32 s13, s33, s35
    s_mov_b32 s14, 1605632
    s_mov_b32 s15, 0x20000
    s_add_u32 m0, s22, 0
    s_nop 0
    buffer_load_dwordx4 v76, s[8:11], s20 offen offset:0 lds
    buffer_load_dwordx4 v77, s[8:11], s20 offen offset:1024 lds
    buffer_load_dwordx4 v78, s[8:11], s20 offen offset:2048 lds
    buffer_load_dwordx4 v79, s[8:11], s20 offen offset:3072 lds
    s_mov_b32 s20, s58
    s_add_u32 m0, s23, 0
    s_nop 0
    buffer_load_dwordx4 v72, s[12:15], s21 offen offset:0 lds
    buffer_load_dwordx4 v73, s[12:15], s21 offen offset:1024 lds
    buffer_load_dwordx4 v74, s[12:15], s21 offen offset:2048 lds
    buffer_load_dwordx4 v75, s[12:15], s21 offen offset:3072 lds
    s_add_u32 s21, s21, 114688
    s_sub_u32 s25, s21, 1376256
    s_cmp_ge_u32 s21, s27
    s_cselect_b32 s21, s25, s21
    s_add_u32 m0, s23, 16384
    s_nop 0
    buffer_load_dwordx4 v72, s[12:15], s21 offen offset:0 lds
    buffer_load_dwordx4 v73, s[12:15], s21 offen offset:1024 lds
    buffer_load_dwordx4 v74, s[12:15], s21 offen offset:2048 lds
    buffer_load_dwordx4 v75, s[12:15], s21 offen offset:3072 lds
    s_mov_b32 s21, s59
    s_add_u32 m0, s22, 16384
    s_nop 0
    buffer_load_dwordx4 v76, s[8:11], s20 offen offset:0 lds
    buffer_load_dwordx4 v77, s[8:11], s20 offen offset:1024 lds
    buffer_load_dwordx4 v78, s[8:11], s20 offen offset:2048 lds
    buffer_load_dwordx4 v79, s[8:11], s20 offen offset:3072 lds
    s_add_u32 s20, s20, 128
    s_sub_u32 s25, s20, 768
    s_cmp_ge_u32 s20, s26
    s_cselect_b32 s20, s25, s20
    s_mov_b32 s16, s30
    s_mov_b32 s17, s31
    s_mov_b32 s18, 7340032
    s_mov_b32 s19, 0x20000
    s_add_u32 s52, s30, 14876672
    s_addc_u32 s53, s31, 0
    s_mov_b32 s54, 114688
    s_mov_b32 s55, 0x20000
    s_load_dwordx2 s[28:29], s[0:1], 120
    s_sub_u32 s57, s41, 4
    s_lshl_b32 s56, s57, 3
    s_add_u32 s56, s56, s40
    s_add_u32 s56, s56, 672
    s_lshl_b32 s56, s56, 7
    s_cmp_lt_u32 s57, 28
    s_cselect_b32 s56, s56, 114688
    v_mov_b32 v21, 0
    s_waitcnt lgkmcnt(0)
    v_lshrrev_b32 v10, 4, v0
    v_lshrrev_b32 v11, 2, v0
    v_and_b32 v11, 3, v11
    v_and_b32 v12, 3, v0
    v_lshrrev_b32 v13, 1, v10
    v_and_b32 v10, 1, v10
    v_lshlrev_b32 v18, 13, v10
    v_lshlrev_b32 v19, 3, v13
    v_add_u32 v19, v19, v11
    v_lshlrev_b32 v19, 8, v19
    v_add_u32 v18, v18, v19
    v_lshrrev_b32 v19, 1, v12
    v_lshlrev_b32 v19, 3, v19
    v_add_u32 v18, v18, v19
    v_and_b32 v19, 1, v12
    v_lshlrev_b32 v20, 1, v11
    v_xor_b32 v19, v19, v20
    v_lshlrev_b32 v20, 3, v10
    v_xor_b32 v19, v19, v20
    s_lshr_b32 s24, s4, 1
    s_lshl_b32 s24, s24, 3
    s_add_u32 s25, s24, 0
    v_xor_b32 v20, s25, v19
    v_lshlrev_b32 v20, 4, v20
    v_add_u32 v5, v18, v20
    s_add_u32 s25, s24, 2
    v_xor_b32 v20, s25, v19
    v_lshlrev_b32 v20, 4, v20
    v_add_u32 v6, v18, v20
    s_add_u32 s25, s24, 4
    v_xor_b32 v20, s25, v19
    v_lshlrev_b32 v20, 4, v20
    v_add_u32 v7, v18, v20
    s_add_u32 s25, s24, 6
    v_xor_b32 v20, s25, v19
    v_lshlrev_b32 v20, 4, v20
    v_add_u32 v8, v18, v20
    v_and_b32 v10, 31, v0
    v_lshrrev_b32 v11, 5, v0
    v_lshrrev_b32 v12, 1, v10
    v_and_b32 v12, 7, v12
    v_xor_b32 v12, v12, v11
    s_and_b32 s24, s4, 1
    s_lshl_b32 s24, s24, 13
    s_add_u32 s24, s24, 49152
    v_lshlrev_b32 v10, 7, v10
    v_add_u32 v10, s24, v10
    v_xor_b32 v13, 0, v12
    v_lshlrev_b32 v13, 4, v13
    v_add_u32 v14, v10, v13
    v_xor_b32 v13, 2, v12
    v_lshlrev_b32 v13, 4, v13
    v_add_u32 v15, v10, v13
    v_xor_b32 v13, 4, v12
    v_lshlrev_b32 v13, 4, v13
    v_add_u32 v16, v10, v13
    v_xor_b32 v13, 6, v12
    v_lshlrev_b32 v13, 4, v13
    v_add_u32 v17, v10, v13
    v_and_b32 v10, 31, v0
    v_lshrrev_b32 v11, 5, v0
    v_and_b32 v12, 7, v10
    v_xor_b32 v12, v12, v11
    s_lshl_b32 s24, s4, 13
    v_lshlrev_b32 v10, 7, v10
    v_add_u32 v10, s24, v10
    v_xor_b32 v13, 0, v12
    v_lshlrev_b32 v13, 4, v13
    v_add_u32 v91, v10, v13
    v_xor_b32 v13, 2, v12
    v_lshlrev_b32 v13, 4, v13
    v_add_u32 v92, v10, v13
    v_xor_b32 v13, 4, v12
    v_lshlrev_b32 v13, 4, v13
    v_add_u32 v93, v10, v13
    v_xor_b32 v13, 6, v12
    v_lshlrev_b32 v13, 4, v13
    v_add_u32 v94, v10, v13
    v_lshrrev_b32 v10, 3, v0
    v_and_b32 v11, 7, v0
    v_xor_b32 v11, v11, v10
    v_lshlrev_b32 v11, 4, v11
    v_mul_u32_u24 v13, 3584, v10
    v_add_u32 v95, v11, v13
    v_lshlrev_b32 v96, 4, v0
    v_add_u32 v96, s24, v96
    s_and_b32 s25, s4, 1
    s_lshl_b32 s25, s25, 6
    s_add_u32 s25, s25, s5
    s_mul_i32 s25, s25, 3584
    s_lshr_b32 s24, s4, 1
    s_lshl_b32 s24, s24, 6
    s_add_u32 s24, s24, s6
    s_lshl_b32 s24, s24, 1
    s_add_u32 s25, s25, s24
    s_mov_b32 s30, s25
    s_load_dwordx2 s[92:93], s[0:1], 96
    v_lshrrev_b32 v10, 4, v0
    v_lshrrev_b32 v11, 3, v0
    v_and_b32 v12, 7, v0
    v_and_b32 v13, 1, v10
    v_lshlrev_b32 v13, 2, v13
    v_xor_b32 v13, v13, v12
    v_lshlrev_b32 v13, 4, v13
    v_mul_u32_u24 v12, 896, v11
    v_add_u32 v20, v12, v13
    v_add_u32 v19, 6144, v20
    s_lshr_b32 s99, s3, 3
    s_and_b32 s100, s99, 3
    s_mul_i32 s100, s100, 3
    s_lshr_b32 s99, s99, 2
    s_lshl_b32 s101, s99, 1
    s_add_u32 s100, s100, s101
    s_sub_u32 s101, s100, 14
    s_cmp_ge_u32 s100, 14
    s_cselect_b32 s100, s101, s100
    s_mov_b32 s38, s100
    s_and_b32 s101, s3, 1
    s_mul_i32 s39, s101, 14
    s_lshl_b32 s101, s4, 4
    s_mul_i32 s47, s101, 896
    s_lshl_b32 s99, s99, 7
    s_add_u32 s47, s47, s99
    s_add_u32 s99, s39, 14
    s_mul_i32 s99, s99, 57344
    s_add_u32 s97, s47, s99
    s_add_u32 s99, s39, s100
    s_mul_i32 s99, s99, 57344
    s_add_u32 s96, s47, s99
    s_lshl_b32 s98, s4, 11
    s_waitcnt lgkmcnt(0)
    s_mov_b32 s94, 1605632
    s_mov_b32 s95, 0x20000
    s_load_dwordx2 s[100:101], s[0:1], 128
    s_and_b32 s99, s3, 7
    s_lshl_b32 s99, s99, 2
    s_lshr_b32 s45, s3, 3
    s_and_b32 s44, s45, 3
    s_add_u32 s99, s99, s44
    s_lshr_b32 s45, s45, 2
    s_mul_i32 s41, s99, 7
    s_add_u32 s41, s41, s45
    s_lshl_b32 s41, s41, 7
    s_lshl_b32 s44, s99, 6
    s_lshl_b32 s45, s45, 6
    s_lshl_b32 s99, s4, 4
    s_add_u32 s40, s44, s99
    s_mul_i32 s40, s40, 3584
    s_add_u32 s99, s39, 14
    s_lshl_b32 s99, s99, 7
    s_add_u32 s43, s40, s99
    s_add_u32 s99, s39, s38
    s_lshl_b32 s99, s99, 7
    s_add_u32 s42, s40, s99
    s_lshr_b32 s46, s39, 1
    s_lshl_b32 s46, 0x7f, s46
    v_lshrrev_b32 v10, 4, v0
    v_lshrrev_b32 v11, 3, v0
    v_and_b32 v12, 7, v0
    v_xor_b32 v13, v12, v10
    v_lshlrev_b32 v13, 4, v13
    v_mul_u32_u24 v9, 3584, v11
    v_add_u32 v86, v9, v13
    v_xor_b32 v13, 64, v13
    v_add_u32 v87, v9, v13
    v_add_u32 v87, 27648, v87
    v_and_b32 v10, 31, v0
    v_lshrrev_b32 v11, 5, v0
    v_lshrrev_b32 v12, 1, v10
    v_and_b32 v12, 7, v12
    s_lshl_b32 s99, s4, 1
    v_add_u32 v11, s99, v11
    v_xor_b32 v12, v12, v11
    v_lshlrev_b32 v12, 4, v12
    v_lshlrev_b32 v10, 7, v10
    v_add_u32 v88, v10, v12
    v_lshrrev_b32 v10, 4, v0
    v_lshrrev_b32 v11, 2, v0
    v_and_b32 v11, 3, v11
    v_and_b32 v12, 3, v0
    v_lshrrev_b32 v13, 1, v10
    v_lshlrev_b32 v13, 3, v13
    v_add_u32 v13, v13, v11
    s_lshl_b32 s99, s4, 4
    v_add_u32 v13, s99, v13
    v_lshlrev_b32 v13, 7, v13
    v_lshrrev_b32 v9, 1, v12
    v_lshlrev_b32 v9, 3, v9
    v_add_u32 v13, v13, v9
    v_and_b32 v9, 1, v10
    v_lshlrev_b32 v9, 1, v9
    v_and_b32 v18, 1, v12
    v_add_u32 v9, v9, v18
    v_lshrrev_b32 v18, 1, v11
    v_lshlrev_b32 v18, 2, v18
    v_xor_b32 v9, v9, v18
    v_lshlrev_b32 v18, 4, v9
    v_add_u32 v89, v13, v18
    v_xor_b32 v18, 64, v18
    v_add_u32 v90, v13, v18
    s_waitcnt lgkmcnt(0)
    s_add_u32 s48, s100, 14876672
    s_addc_u32 s49, s101, 0
    s_mov_b32 s50, 114688
    s_mov_b32 s51, 0x20000
    s_waitcnt vmcnt(8)
    s_barrier
    ds_read_b128 v[40:43], v14 offset:0
    ds_read_b64_tr_b16 v[24:25], v5 offset:0
    ds_read_b64_tr_b16 v[26:27], v5 offset:1024
    ds_read_b64_tr_b16 v[28:29], v6 offset:0
    ds_read_b64_tr_b16 v[30:31], v6 offset:1024
    ds_read_b128 v[44:47], v14 offset:4096
    ds_read_b64_tr_b16 v[32:33], v7 offset:0
    ds_read_b64_tr_b16 v[34:35], v7 offset:1024
    ds_read_b64_tr_b16 v[36:37], v8 offset:0
    ds_read_b64_tr_b16 v[38:39], v8 offset:1024
    s_add_u32 m0, s23, 32768
    s_nop 0
    buffer_load_dwordx4 v72, s[12:15], s21 offen offset:0 lds
    buffer_load_dwordx4 v73, s[12:15], s21 offen offset:1024 lds
    buffer_load_dwordx4 v74, s[12:15], s21 offen offset:2048 lds
    buffer_load_dwordx4 v75, s[12:15], s21 offen offset:3072 lds
    s_add_u32 s21, s21, 114688
    s_sub_u32 s25, s21, 1376256
    s_cmp_ge_u32 s21, s27
    s_cselect_b32 s21, s25, s21
    s_waitcnt lgkmcnt(0)
    v_mfma_f32_32x32x16_bf16 v[128:143], v[24:27], v[40:43], 0
    ds_read_b128 v[64:67], v15 offset:0
    ds_read_b64_tr_b16 v[48:49], v5 offset:4096
    v_mfma_f32_32x32x16_bf16 v[160:175], v[28:31], v[40:43], 0
    ds_read_b64_tr_b16 v[50:51], v5 offset:5120
    ds_read_b64_tr_b16 v[52:53], v6 offset:4096
    v_mfma_f32_32x32x16_bf16 v[144:159], v[24:27], v[44:47], 0
    ds_read_b64_tr_b16 v[54:55], v6 offset:5120
    ds_read_b128 v[68:71], v15 offset:4096
    v_mfma_f32_32x32x16_bf16 v[176:191], v[28:31], v[44:47], 0
    ds_read_b64_tr_b16 v[56:57], v7 offset:4096
    ds_read_b64_tr_b16 v[58:59], v7 offset:5120
    v_mfma_f32_32x32x16_bf16 v[192:207], v[32:35], v[40:43], 0
    ds_read_b64_tr_b16 v[60:61], v8 offset:4096
    ds_read_b64_tr_b16 v[62:63], v8 offset:5120
    v_mfma_f32_32x32x16_bf16 v[208:223], v[32:35], v[44:47], 0
    v_mfma_f32_32x32x16_bf16 v[224:239], v[36:39], v[40:43], 0
    v_mfma_f32_32x32x16_bf16 v[240:255], v[36:39], v[44:47], 0
    s_waitcnt lgkmcnt(0)
    s_waitcnt vmcnt(8)
    s_barrier
    v_mfma_f32_32x32x16_bf16 v[128:143], v[48:51], v[64:67], v[128:143]
    ds_read_b128 v[40:43], v16 offset:0
    ds_read_b64_tr_b16 v[24:25], v5 offset:16384
    v_mfma_f32_32x32x16_bf16 v[160:175], v[52:55], v[64:67], v[160:175]
    s_add_u32 m0, s23, 0
    s_nop 0
    buffer_load_dwordx4 v72, s[12:15], s21 offen offset:0 lds
    ds_read_b64_tr_b16 v[26:27], v5 offset:17408
    ds_read_b64_tr_b16 v[28:29], v6 offset:16384
    v_mfma_f32_32x32x16_bf16 v[144:159], v[48:51], v[68:71], v[144:159]
    ds_read_b64_tr_b16 v[30:31], v6 offset:17408
    ds_read_b128 v[44:47], v16 offset:4096
    v_mfma_f32_32x32x16_bf16 v[176:191], v[52:55], v[68:71], v[176:191]
    buffer_load_dwordx4 v73, s[12:15], s21 offen offset:1024 lds
    ds_read_b64_tr_b16 v[32:33], v7 offset:16384
    ds_read_b64_tr_b16 v[34:35], v7 offset:17408
    v_mfma_f32_32x32x16_bf16 v[192:207], v[56:59], v[64:67], v[192:207]
    ds_read_b64_tr_b16 v[36:37], v8 offset:16384
    ds_read_b64_tr_b16 v[38:39], v8 offset:17408
    v_mfma_f32_32x32x16_bf16 v[208:223], v[56:59], v[68:71], v[208:223]
    buffer_load_dwordx4 v74, s[12:15], s21 offen offset:2048 lds
    v_mfma_f32_32x32x16_bf16 v[224:239], v[60:63], v[64:67], v[224:239]
    v_mfma_f32_32x32x16_bf16 v[240:255], v[60:63], v[68:71], v[240:255]
    buffer_load_dwordx4 v75, s[12:15], s21 offen offset:3072 lds
    s_add_u32 s21, s21, 114688
    s_sub_u32 s25, s21, 1376256
    s_cmp_ge_u32 s21, s27
    s_cselect_b32 s21, s25, s21
    s_waitcnt lgkmcnt(0)
    v_mfma_f32_32x32x16_bf16 v[128:143], v[24:27], v[40:43], v[128:143]
    ds_read_b128 v[64:67], v17 offset:0
    ds_read_b64_tr_b16 v[48:49], v5 offset:20480
    v_mfma_f32_32x32x16_bf16 v[160:175], v[28:31], v[40:43], v[160:175]
    ds_read_b64_tr_b16 v[50:51], v5 offset:21504
    ds_read_b64_tr_b16 v[52:53], v6 offset:20480
    v_mfma_f32_32x32x16_bf16 v[144:159], v[24:27], v[44:47], v[144:159]
    ds_read_b64_tr_b16 v[54:55], v6 offset:21504
    ds_read_b128 v[68:71], v17 offset:4096
    v_mfma_f32_32x32x16_bf16 v[176:191], v[28:31], v[44:47], v[176:191]
    ds_read_b64_tr_b16 v[56:57], v7 offset:20480
    ds_read_b64_tr_b16 v[58:59], v7 offset:21504
    v_mfma_f32_32x32x16_bf16 v[192:207], v[32:35], v[40:43], v[192:207]
    ds_read_b64_tr_b16 v[60:61], v8 offset:20480
    ds_read_b64_tr_b16 v[62:63], v8 offset:21504
    v_mfma_f32_32x32x16_bf16 v[208:223], v[32:35], v[44:47], v[208:223]
    v_mfma_f32_32x32x16_bf16 v[224:239], v[36:39], v[40:43], v[224:239]
    v_mfma_f32_32x32x16_bf16 v[240:255], v[36:39], v[44:47], v[240:255]
    s_waitcnt lgkmcnt(0)
    s_waitcnt vmcnt(4)
    s_barrier
    v_mfma_f32_32x32x16_bf16 v[128:143], v[48:51], v[64:67], v[128:143]
    ds_read_b128 v[40:43], v14 offset:16384
    ds_read_b64_tr_b16 v[24:25], v5 offset:32768
    v_mfma_f32_32x32x16_bf16 v[160:175], v[52:55], v[64:67], v[160:175]
    s_add_u32 m0, s23, 16384
    s_nop 0
    buffer_load_dwordx4 v72, s[12:15], s21 offen offset:0 lds
    ds_read_b64_tr_b16 v[26:27], v5 offset:33792
    ds_read_b64_tr_b16 v[28:29], v6 offset:32768
    v_mfma_f32_32x32x16_bf16 v[144:159], v[48:51], v[68:71], v[144:159]
    ds_read_b64_tr_b16 v[30:31], v6 offset:33792
    ds_read_b128 v[44:47], v14 offset:20480
    v_mfma_f32_32x32x16_bf16 v[176:191], v[52:55], v[68:71], v[176:191]
    buffer_load_dwordx4 v73, s[12:15], s21 offen offset:1024 lds
    ds_read_b64_tr_b16 v[32:33], v7 offset:32768
    ds_read_b64_tr_b16 v[34:35], v7 offset:33792
    v_mfma_f32_32x32x16_bf16 v[192:207], v[56:59], v[64:67], v[192:207]
    ds_read_b64_tr_b16 v[36:37], v8 offset:32768
    ds_read_b64_tr_b16 v[38:39], v8 offset:33792
    v_mfma_f32_32x32x16_bf16 v[208:223], v[56:59], v[68:71], v[208:223]
    buffer_load_dwordx4 v74, s[12:15], s21 offen offset:2048 lds
    v_mfma_f32_32x32x16_bf16 v[224:239], v[60:63], v[64:67], v[224:239]
    v_mfma_f32_32x32x16_bf16 v[240:255], v[60:63], v[68:71], v[240:255]
    buffer_load_dwordx4 v75, s[12:15], s21 offen offset:3072 lds
    s_add_u32 s21, s21, 114688
    s_sub_u32 s25, s21, 1376256
    s_cmp_ge_u32 s21, s27
    s_cselect_b32 s21, s25, s21
    s_waitcnt lgkmcnt(0)
    v_mfma_f32_32x32x16_bf16 v[128:143], v[24:27], v[40:43], v[128:143]
    ds_read_b128 v[64:67], v15 offset:16384
    ds_read_b64_tr_b16 v[48:49], v5 offset:36864
    v_mfma_f32_32x32x16_bf16 v[160:175], v[28:31], v[40:43], v[160:175]
    s_add_u32 m0, s22, 0
    s_nop 0
    buffer_load_dwordx4 v76, s[8:11], s20 offen offset:0 lds
    ds_read_b64_tr_b16 v[50:51], v5 offset:37888
    ds_read_b64_tr_b16 v[52:53], v6 offset:36864
    v_mfma_f32_32x32x16_bf16 v[144:159], v[24:27], v[44:47], v[144:159]
    ds_read_b64_tr_b16 v[54:55], v6 offset:37888
    ds_read_b128 v[68:71], v15 offset:20480
    v_mfma_f32_32x32x16_bf16 v[176:191], v[28:31], v[44:47], v[176:191]
    buffer_load_dwordx4 v77, s[8:11], s20 offen offset:1024 lds
    ds_read_b64_tr_b16 v[56:57], v7 offset:36864
    ds_read_b64_tr_b16 v[58:59], v7 offset:37888
    v_mfma_f32_32x32x16_bf16 v[192:207], v[32:35], v[40:43], v[192:207]
    ds_read_b64_tr_b16 v[60:61], v8 offset:36864
    ds_read_b64_tr_b16 v[62:63], v8 offset:37888
    v_mfma_f32_32x32x16_bf16 v[208:223], v[32:35], v[44:47], v[208:223]
    buffer_load_dwordx4 v78, s[8:11], s20 offen offset:2048 lds
    v_mfma_f32_32x32x16_bf16 v[224:239], v[36:39], v[40:43], v[224:239]
    v_mfma_f32_32x32x16_bf16 v[240:255], v[36:39], v[44:47], v[240:255]
    buffer_load_dwordx4 v79, s[8:11], s20 offen offset:3072 lds
    s_add_u32 s20, s20, 128
    s_sub_u32 s25, s20, 768
    s_cmp_ge_u32 s20, s26
    s_cselect_b32 s20, s25, s20
    s_waitcnt lgkmcnt(0)
    s_waitcnt vmcnt(8)
    s_barrier
    global_load_dword v23, v21, s[28:29] sc1
    v_mfma_f32_32x32x16_bf16 v[128:143], v[48:51], v[64:67], v[128:143]
    ds_read_b128 v[40:43], v16 offset:16384
    ds_read_b64_tr_b16 v[24:25], v5 offset:0
    v_mfma_f32_32x32x16_bf16 v[160:175], v[52:55], v[64:67], v[160:175]
    s_add_u32 m0, s23, 32768
    s_nop 0
    buffer_load_dwordx4 v72, s[12:15], s21 offen offset:0 lds
    ds_read_b64_tr_b16 v[26:27], v5 offset:1024
    ds_read_b64_tr_b16 v[28:29], v6 offset:0
    v_mfma_f32_32x32x16_bf16 v[144:159], v[48:51], v[68:71], v[144:159]
    ds_read_b64_tr_b16 v[30:31], v6 offset:1024
    ds_read_b128 v[44:47], v16 offset:20480
    v_mfma_f32_32x32x16_bf16 v[176:191], v[52:55], v[68:71], v[176:191]
    buffer_load_dwordx4 v73, s[12:15], s21 offen offset:1024 lds
    ds_read_b64_tr_b16 v[32:33], v7 offset:0
    ds_read_b64_tr_b16 v[34:35], v7 offset:1024
    v_mfma_f32_32x32x16_bf16 v[192:207], v[56:59], v[64:67], v[192:207]
    ds_read_b64_tr_b16 v[36:37], v8 offset:0
    ds_read_b64_tr_b16 v[38:39], v8 offset:1024
    v_mfma_f32_32x32x16_bf16 v[208:223], v[56:59], v[68:71], v[208:223]
    buffer_load_dwordx4 v74, s[12:15], s21 offen offset:2048 lds
    v_mfma_f32_32x32x16_bf16 v[224:239], v[60:63], v[64:67], v[224:239]
    v_mfma_f32_32x32x16_bf16 v[240:255], v[60:63], v[68:71], v[240:255]
    buffer_load_dwordx4 v75, s[12:15], s21 offen offset:3072 lds
    s_add_u32 s21, s21, 114688
    s_sub_u32 s25, s21, 1376256
    s_cmp_ge_u32 s21, s27
    s_cselect_b32 s21, s25, s21
    s_waitcnt lgkmcnt(0)
    v_mfma_f32_32x32x16_bf16 v[128:143], v[24:27], v[40:43], v[128:143]
    ds_read_b128 v[64:67], v17 offset:16384
    ds_read_b64_tr_b16 v[48:49], v5 offset:4096
    v_mfma_f32_32x32x16_bf16 v[160:175], v[28:31], v[40:43], v[160:175]
    ds_read_b64_tr_b16 v[50:51], v5 offset:5120
    ds_read_b64_tr_b16 v[52:53], v6 offset:4096
    v_mfma_f32_32x32x16_bf16 v[144:159], v[24:27], v[44:47], v[144:159]
    ds_read_b64_tr_b16 v[54:55], v6 offset:5120
    ds_read_b128 v[68:71], v17 offset:20480
    v_mfma_f32_32x32x16_bf16 v[176:191], v[28:31], v[44:47], v[176:191]
    ds_read_b64_tr_b16 v[56:57], v7 offset:4096
    ds_read_b64_tr_b16 v[58:59], v7 offset:5120
    v_mfma_f32_32x32x16_bf16 v[192:207], v[32:35], v[40:43], v[192:207]
    ds_read_b64_tr_b16 v[60:61], v8 offset:4096
    ds_read_b64_tr_b16 v[62:63], v8 offset:5120
    v_mfma_f32_32x32x16_bf16 v[208:223], v[32:35], v[44:47], v[208:223]
    v_mfma_f32_32x32x16_bf16 v[224:239], v[36:39], v[40:43], v[224:239]
    v_mfma_f32_32x32x16_bf16 v[240:255], v[36:39], v[44:47], v[240:255]
    s_waitcnt lgkmcnt(0)
    s_waitcnt vmcnt(5)
    s_barrier
    v_mfma_f32_32x32x16_bf16 v[128:143], v[48:51], v[64:67], v[128:143]
    ds_read_b128 v[40:43], v14 offset:0
    ds_read_b64_tr_b16 v[24:25], v5 offset:16384
    v_mfma_f32_32x32x16_bf16 v[160:175], v[52:55], v[64:67], v[160:175]
    s_add_u32 m0, s23, 0
    s_nop 0
    buffer_load_dwordx4 v72, s[12:15], s21 offen offset:0 lds
    ds_read_b64_tr_b16 v[26:27], v5 offset:17408
    ds_read_b64_tr_b16 v[28:29], v6 offset:16384
    v_mfma_f32_32x32x16_bf16 v[144:159], v[48:51], v[68:71], v[144:159]
    ds_read_b64_tr_b16 v[30:31], v6 offset:17408
    ds_read_b128 v[44:47], v14 offset:4096
    v_mfma_f32_32x32x16_bf16 v[176:191], v[52:55], v[68:71], v[176:191]
    buffer_load_dwordx4 v73, s[12:15], s21 offen offset:1024 lds
    ds_read_b64_tr_b16 v[32:33], v7 offset:16384
    ds_read_b64_tr_b16 v[34:35], v7 offset:17408
    v_mfma_f32_32x32x16_bf16 v[192:207], v[56:59], v[64:67], v[192:207]
    ds_read_b64_tr_b16 v[36:37], v8 offset:16384
    ds_read_b64_tr_b16 v[38:39], v8 offset:17408
    v_mfma_f32_32x32x16_bf16 v[208:223], v[56:59], v[68:71], v[208:223]
    buffer_load_dwordx4 v74, s[12:15], s21 offen offset:2048 lds
    v_mfma_f32_32x32x16_bf16 v[224:239], v[60:63], v[64:67], v[224:239]
    v_mfma_f32_32x32x16_bf16 v[240:255], v[60:63], v[68:71], v[240:255]
    buffer_load_dwordx4 v75, s[12:15], s21 offen offset:3072 lds
    s_add_u32 s21, s21, 114688
    s_sub_u32 s25, s21, 1376256
    s_cmp_ge_u32 s21, s27
    s_cselect_b32 s21, s25, s21
    s_waitcnt lgkmcnt(0)
    v_mfma_f32_32x32x16_bf16 v[128:143], v[24:27], v[40:43], v[128:143]
    ds_read_b128 v[64:67], v15 offset:0
    ds_read_b64_tr_b16 v[48:49], v5 offset:20480
    v_mfma_f32_32x32x16_bf16 v[160:175], v[28:31], v[40:43], v[160:175]
    s_add_u32 m0, s22, 16384
    s_nop 0
    buffer_load_dwordx4 v76, s[8:11], s20 offen offset:0 lds
    ds_read_b64_tr_b16 v[50:51], v5 offset:21504
    ds_read_b64_tr_b16 v[52:53], v6 offset:20480
    v_mfma_f32_32x32x16_bf16 v[144:159], v[24:27], v[44:47], v[144:159]
    ds_read_b64_tr_b16 v[54:55], v6 offset:21504
    ds_read_b128 v[68:71], v15 offset:4096
    v_mfma_f32_32x32x16_bf16 v[176:191], v[28:31], v[44:47], v[176:191]
    buffer_load_dwordx4 v77, s[8:11], s20 offen offset:1024 lds
    ds_read_b64_tr_b16 v[56:57], v7 offset:20480
    ds_read_b64_tr_b16 v[58:59], v7 offset:21504
    v_mfma_f32_32x32x16_bf16 v[192:207], v[32:35], v[40:43], v[192:207]
    ds_read_b64_tr_b16 v[60:61], v8 offset:20480
    ds_read_b64_tr_b16 v[62:63], v8 offset:21504
    v_mfma_f32_32x32x16_bf16 v[208:223], v[32:35], v[44:47], v[208:223]
    buffer_load_dwordx4 v78, s[8:11], s20 offen offset:2048 lds
    v_mfma_f32_32x32x16_bf16 v[224:239], v[36:39], v[40:43], v[224:239]
    v_mfma_f32_32x32x16_bf16 v[240:255], v[36:39], v[44:47], v[240:255]
    buffer_load_dwordx4 v79, s[8:11], s20 offen offset:3072 lds
    s_add_u32 s20, s20, 128
    s_sub_u32 s25, s20, 768
    s_cmp_ge_u32 s20, s26
    s_cselect_b32 s20, s25, s20
    s_waitcnt lgkmcnt(0)
    s_waitcnt vmcnt(8)
    s_barrier
    v_mfma_f32_32x32x16_bf16 v[128:143], v[48:51], v[64:67], v[128:143]
    ds_read_b128 v[40:43], v16 offset:0
    ds_read_b64_tr_b16 v[24:25], v5 offset:32768
    v_mfma_f32_32x32x16_bf16 v[160:175], v[52:55], v[64:67], v[160:175]
    s_add_u32 m0, s23, 16384
    s_nop 0
    buffer_load_dwordx4 v72, s[12:15], s21 offen offset:0 lds
    ds_read_b64_tr_b16 v[26:27], v5 offset:33792
    ds_read_b64_tr_b16 v[28:29], v6 offset:32768
    v_mfma_f32_32x32x16_bf16 v[144:159], v[48:51], v[68:71], v[144:159]
    ds_read_b64_tr_b16 v[30:31], v6 offset:33792
    ds_read_b128 v[44:47], v16 offset:4096
    v_mfma_f32_32x32x16_bf16 v[176:191], v[52:55], v[68:71], v[176:191]
    buffer_load_dwordx4 v73, s[12:15], s21 offen offset:1024 lds
    ds_read_b64_tr_b16 v[32:33], v7 offset:32768
    ds_read_b64_tr_b16 v[34:35], v7 offset:33792
    v_mfma_f32_32x32x16_bf16 v[192:207], v[56:59], v[64:67], v[192:207]
    ds_read_b64_tr_b16 v[36:37], v8 offset:32768
    ds_read_b64_tr_b16 v[38:39], v8 offset:33792
    v_mfma_f32_32x32x16_bf16 v[208:223], v[56:59], v[68:71], v[208:223]
    buffer_load_dwordx4 v74, s[12:15], s21 offen offset:2048 lds
    v_mfma_f32_32x32x16_bf16 v[224:239], v[60:63], v[64:67], v[224:239]
    v_mfma_f32_32x32x16_bf16 v[240:255], v[60:63], v[68:71], v[240:255]
    buffer_load_dwordx4 v75, s[12:15], s21 offen offset:3072 lds
    s_add_u32 s21, s21, 114688
    s_sub_u32 s25, s21, 1376256
    s_cmp_ge_u32 s21, s27
    s_cselect_b32 s21, s25, s21
    s_waitcnt lgkmcnt(0)
    v_mfma_f32_32x32x16_bf16 v[128:143], v[24:27], v[40:43], v[128:143]
    ds_read_b128 v[64:67], v17 offset:0
    ds_read_b64_tr_b16 v[48:49], v5 offset:36864
    v_mfma_f32_32x32x16_bf16 v[160:175], v[28:31], v[40:43], v[160:175]
    ds_read_b64_tr_b16 v[50:51], v5 offset:37888
    ds_read_b64_tr_b16 v[52:53], v6 offset:36864
    v_mfma_f32_32x32x16_bf16 v[144:159], v[24:27], v[44:47], v[144:159]
    ds_read_b64_tr_b16 v[54:55], v6 offset:37888
    ds_read_b128 v[68:71], v17 offset:4096
    v_mfma_f32_32x32x16_bf16 v[176:191], v[28:31], v[44:47], v[176:191]
    ds_read_b64_tr_b16 v[56:57], v7 offset:36864
    ds_read_b64_tr_b16 v[58:59], v7 offset:37888
    v_mfma_f32_32x32x16_bf16 v[192:207], v[32:35], v[40:43], v[192:207]
    ds_read_b64_tr_b16 v[60:61], v8 offset:36864
    ds_read_b64_tr_b16 v[62:63], v8 offset:37888
    v_mfma_f32_32x32x16_bf16 v[208:223], v[32:35], v[44:47], v[208:223]
    v_mfma_f32_32x32x16_bf16 v[224:239], v[36:39], v[40:43], v[224:239]
    v_mfma_f32_32x32x16_bf16 v[240:255], v[36:39], v[44:47], v[240:255]
    s_waitcnt lgkmcnt(0)
    s_waitcnt vmcnt(4)
    s_barrier
    v_mfma_f32_32x32x16_bf16 v[128:143], v[48:51], v[64:67], v[128:143]
    ds_read_b128 v[40:43], v14 offset:16384
    ds_read_b64_tr_b16 v[24:25], v5 offset:0
    v_mfma_f32_32x32x16_bf16 v[160:175], v[52:55], v[64:67], v[160:175]
    s_add_u32 m0, s23, 32768
    s_nop 0
    buffer_load_dwordx4 v72, s[12:15], s21 offen offset:0 lds
    ds_read_b64_tr_b16 v[26:27], v5 offset:1024
    ds_read_b64_tr_b16 v[28:29], v6 offset:0
    v_mfma_f32_32x32x16_bf16 v[144:159], v[48:51], v[68:71], v[144:159]
    ds_read_b64_tr_b16 v[30:31], v6 offset:1024
    ds_read_b128 v[44:47], v14 offset:20480
    v_mfma_f32_32x32x16_bf16 v[176:191], v[52:55], v[68:71], v[176:191]
    buffer_load_dwordx4 v73, s[12:15], s21 offen offset:1024 lds
    ds_read_b64_tr_b16 v[32:33], v7 offset:0
    ds_read_b64_tr_b16 v[34:35], v7 offset:1024
    v_mfma_f32_32x32x16_bf16 v[192:207], v[56:59], v[64:67], v[192:207]
    ds_read_b64_tr_b16 v[36:37], v8 offset:0
    ds_read_b64_tr_b16 v[38:39], v8 offset:1024
    v_mfma_f32_32x32x16_bf16 v[208:223], v[56:59], v[68:71], v[208:223]
    buffer_load_dwordx4 v74, s[12:15], s21 offen offset:2048 lds
    v_mfma_f32_32x32x16_bf16 v[224:239], v[60:63], v[64:67], v[224:239]
    v_mfma_f32_32x32x16_bf16 v[240:255], v[60:63], v[68:71], v[240:255]
    buffer_load_dwordx4 v75, s[12:15], s21 offen offset:3072 lds
    s_add_u32 s21, s21, 114688
    s_sub_u32 s25, s21, 1376256
    s_cmp_ge_u32 s21, s27
    s_cselect_b32 s21, s25, s21
    s_waitcnt lgkmcnt(0)
    v_mfma_f32_32x32x16_bf16 v[128:143], v[24:27], v[40:43], v[128:143]
    ds_read_b128 v[64:67], v15 offset:16384
    ds_read_b64_tr_b16 v[48:49], v5 offset:4096
    v_mfma_f32_32x32x16_bf16 v[160:175], v[28:31], v[40:43], v[160:175]
    s_add_u32 m0, s22, 0
    s_nop 0
    buffer_load_dwordx4 v76, s[8:11], s20 offen offset:0 lds
    ds_read_b64_tr_b16 v[50:51], v5 offset:5120
    ds_read_b64_tr_b16 v[52:53], v6 offset:4096
    v_mfma_f32_32x32x16_bf16 v[144:159], v[24:27], v[44:47], v[144:159]
    ds_read_b64_tr_b16 v[54:55], v6 offset:5120
    ds_read_b128 v[68:71], v15 offset:20480
    v_mfma_f32_32x32x16_bf16 v[176:191], v[28:31], v[44:47], v[176:191]
    buffer_load_dwordx4 v77, s[8:11], s20 offen offset:1024 lds
    ds_read_b64_tr_b16 v[56:57], v7 offset:4096
    ds_read_b64_tr_b16 v[58:59], v7 offset:5120
    v_mfma_f32_32x32x16_bf16 v[192:207], v[32:35], v[40:43], v[192:207]
    ds_read_b64_tr_b16 v[60:61], v8 offset:4096
    ds_read_b64_tr_b16 v[62:63], v8 offset:5120
    v_mfma_f32_32x32x16_bf16 v[208:223], v[32:35], v[44:47], v[208:223]
    buffer_load_dwordx4 v78, s[8:11], s20 offen offset:2048 lds
    v_mfma_f32_32x32x16_bf16 v[224:239], v[36:39], v[40:43], v[224:239]
    v_mfma_f32_32x32x16_bf16 v[240:255], v[36:39], v[44:47], v[240:255]
    buffer_load_dwordx4 v79, s[8:11], s20 offen offset:3072 lds
    s_add_u32 s20, s20, 128
    s_sub_u32 s25, s20, 768
    s_cmp_ge_u32 s20, s26
    s_cselect_b32 s20, s25, s20
    s_waitcnt lgkmcnt(0)
    s_waitcnt vmcnt(8)
    s_barrier
    v_mfma_f32_32x32x16_bf16 v[128:143], v[48:51], v[64:67], v[128:143]
    ds_read_b128 v[40:43], v16 offset:16384
    ds_read_b64_tr_b16 v[24:25], v5 offset:16384
    v_mfma_f32_32x32x16_bf16 v[160:175], v[52:55], v[64:67], v[160:175]
    s_add_u32 m0, s23, 0
    s_nop 0
    buffer_load_dwordx4 v72, s[12:15], s21 offen offset:0 lds
    ds_read_b64_tr_b16 v[26:27], v5 offset:17408
    ds_read_b64_tr_b16 v[28:29], v6 offset:16384
    v_mfma_f32_32x32x16_bf16 v[144:159], v[48:51], v[68:71], v[144:159]
    ds_read_b64_tr_b16 v[30:31], v6 offset:17408
    ds_read_b128 v[44:47], v16 offset:20480
    v_mfma_f32_32x32x16_bf16 v[176:191], v[52:55], v[68:71], v[176:191]
    buffer_load_dwordx4 v73, s[12:15], s21 offen offset:1024 lds
    ds_read_b64_tr_b16 v[32:33], v7 offset:16384
    ds_read_b64_tr_b16 v[34:35], v7 offset:17408
    v_mfma_f32_32x32x16_bf16 v[192:207], v[56:59], v[64:67], v[192:207]
    ds_read_b64_tr_b16 v[36:37], v8 offset:16384
    ds_read_b64_tr_b16 v[38:39], v8 offset:17408
    v_mfma_f32_32x32x16_bf16 v[208:223], v[56:59], v[68:71], v[208:223]
    buffer_load_dwordx4 v74, s[12:15], s21 offen offset:2048 lds
    v_mfma_f32_32x32x16_bf16 v[224:239], v[60:63], v[64:67], v[224:239]
    v_mfma_f32_32x32x16_bf16 v[240:255], v[60:63], v[68:71], v[240:255]
    buffer_load_dwordx4 v75, s[12:15], s21 offen offset:3072 lds
    s_add_u32 s21, s21, 114688
    s_sub_u32 s25, s21, 1376256
    s_cmp_ge_u32 s21, s27
    s_cselect_b32 s21, s25, s21
    s_waitcnt lgkmcnt(0)
    v_mfma_f32_32x32x16_bf16 v[128:143], v[24:27], v[40:43], v[128:143]
    ds_read_b128 v[64:67], v17 offset:16384
    ds_read_b64_tr_b16 v[48:49], v5 offset:20480
    v_mfma_f32_32x32x16_bf16 v[160:175], v[28:31], v[40:43], v[160:175]
    ds_read_b64_tr_b16 v[50:51], v5 offset:21504
    ds_read_b64_tr_b16 v[52:53], v6 offset:20480
    v_mfma_f32_32x32x16_bf16 v[144:159], v[24:27], v[44:47], v[144:159]
    ds_read_b64_tr_b16 v[54:55], v6 offset:21504
    ds_read_b128 v[68:71], v17 offset:20480
    v_mfma_f32_32x32x16_bf16 v[176:191], v[28:31], v[44:47], v[176:191]
    ds_read_b64_tr_b16 v[56:57], v7 offset:20480
    ds_read_b64_tr_b16 v[58:59], v7 offset:21504
    v_mfma_f32_32x32x16_bf16 v[192:207], v[32:35], v[40:43], v[192:207]
    ds_read_b64_tr_b16 v[60:61], v8 offset:20480
    ds_read_b64_tr_b16 v[62:63], v8 offset:21504
    v_mfma_f32_32x32x16_bf16 v[208:223], v[32:35], v[44:47], v[208:223]
    v_mfma_f32_32x32x16_bf16 v[224:239], v[36:39], v[40:43], v[224:239]
    v_mfma_f32_32x32x16_bf16 v[240:255], v[36:39], v[44:47], v[240:255]
    s_waitcnt lgkmcnt(0)
    s_waitcnt vmcnt(4)
    s_barrier
    v_mfma_f32_32x32x16_bf16 v[128:143], v[48:51], v[64:67], v[128:143]
    ds_read_b128 v[40:43], v14 offset:0
    ds_read_b64_tr_b16 v[24:25], v5 offset:32768
    v_mfma_f32_32x32x16_bf16 v[160:175], v[52:55], v[64:67], v[160:175]
    s_add_u32 m0, s23, 16384
    s_nop 0
    buffer_load_dwordx4 v72, s[12:15], s21 offen offset:0 lds
    ds_read_b64_tr_b16 v[26:27], v5 offset:33792
    ds_read_b64_tr_b16 v[28:29], v6 offset:32768
    v_mfma_f32_32x32x16_bf16 v[144:159], v[48:51], v[68:71], v[144:159]
    ds_read_b64_tr_b16 v[30:31], v6 offset:33792
    ds_read_b128 v[44:47], v14 offset:4096
    v_mfma_f32_32x32x16_bf16 v[176:191], v[52:55], v[68:71], v[176:191]
    buffer_load_dwordx4 v73, s[12:15], s21 offen offset:1024 lds
    ds_read_b64_tr_b16 v[32:33], v7 offset:32768
    ds_read_b64_tr_b16 v[34:35], v7 offset:33792
    v_mfma_f32_32x32x16_bf16 v[192:207], v[56:59], v[64:67], v[192:207]
    ds_read_b64_tr_b16 v[36:37], v8 offset:32768
    ds_read_b64_tr_b16 v[38:39], v8 offset:33792
    v_mfma_f32_32x32x16_bf16 v[208:223], v[56:59], v[68:71], v[208:223]
    buffer_load_dwordx4 v74, s[12:15], s21 offen offset:2048 lds
    v_mfma_f32_32x32x16_bf16 v[224:239], v[60:63], v[64:67], v[224:239]
    v_mfma_f32_32x32x16_bf16 v[240:255], v[60:63], v[68:71], v[240:255]
    buffer_load_dwordx4 v75, s[12:15], s21 offen offset:3072 lds
    s_add_u32 s21, s21, 114688
    s_sub_u32 s25, s21, 1376256
    s_cmp_ge_u32 s21, s27
    s_cselect_b32 s21, s25, s21
    s_waitcnt lgkmcnt(0)
    v_mfma_f32_32x32x16_bf16 v[128:143], v[24:27], v[40:43], v[128:143]
    ds_read_b128 v[64:67], v15 offset:0
    ds_read_b64_tr_b16 v[48:49], v5 offset:36864
    v_mfma_f32_32x32x16_bf16 v[160:175], v[28:31], v[40:43], v[160:175]
    s_add_u32 m0, s22, 16384
    s_nop 0
    buffer_load_dwordx4 v76, s[8:11], s20 offen offset:0 lds
    ds_read_b64_tr_b16 v[50:51], v5 offset:37888
    ds_read_b64_tr_b16 v[52:53], v6 offset:36864
    v_mfma_f32_32x32x16_bf16 v[144:159], v[24:27], v[44:47], v[144:159]
    ds_read_b64_tr_b16 v[54:55], v6 offset:37888
    ds_read_b128 v[68:71], v15 offset:4096
    v_mfma_f32_32x32x16_bf16 v[176:191], v[28:31], v[44:47], v[176:191]
    buffer_load_dwordx4 v77, s[8:11], s20 offen offset:1024 lds
    ds_read_b64_tr_b16 v[56:57], v7 offset:36864
    ds_read_b64_tr_b16 v[58:59], v7 offset:37888
    v_mfma_f32_32x32x16_bf16 v[192:207], v[32:35], v[40:43], v[192:207]
    ds_read_b64_tr_b16 v[60:61], v8 offset:36864
    ds_read_b64_tr_b16 v[62:63], v8 offset:37888
    v_mfma_f32_32x32x16_bf16 v[208:223], v[32:35], v[44:47], v[208:223]
    buffer_load_dwordx4 v78, s[8:11], s20 offen offset:2048 lds
    v_mfma_f32_32x32x16_bf16 v[224:239], v[36:39], v[40:43], v[224:239]
    v_mfma_f32_32x32x16_bf16 v[240:255], v[36:39], v[44:47], v[240:255]
    buffer_load_dwordx4 v79, s[8:11], s20 offen offset:3072 lds
    s_add_u32 s20, s20, 128
    s_sub_u32 s25, s20, 768
    s_cmp_ge_u32 s20, s26
    s_cselect_b32 s20, s25, s20
    s_waitcnt lgkmcnt(0)
    s_waitcnt vmcnt(8)
    s_barrier
    v_mfma_f32_32x32x16_bf16 v[128:143], v[48:51], v[64:67], v[128:143]
    ds_read_b128 v[40:43], v16 offset:0
    ds_read_b64_tr_b16 v[24:25], v5 offset:0
    v_mfma_f32_32x32x16_bf16 v[160:175], v[52:55], v[64:67], v[160:175]
    s_add_u32 m0, s23, 32768
    s_nop 0
    buffer_load_dwordx4 v72, s[12:15], s21 offen offset:0 lds
    ds_read_b64_tr_b16 v[26:27], v5 offset:1024
    ds_read_b64_tr_b16 v[28:29], v6 offset:0
    v_mfma_f32_32x32x16_bf16 v[144:159], v[48:51], v[68:71], v[144:159]
    ds_read_b64_tr_b16 v[30:31], v6 offset:1024
    ds_read_b128 v[44:47], v16 offset:4096
    v_mfma_f32_32x32x16_bf16 v[176:191], v[52:55], v[68:71], v[176:191]
    buffer_load_dwordx4 v73, s[12:15], s21 offen offset:1024 lds
    ds_read_b64_tr_b16 v[32:33], v7 offset:0
    ds_read_b64_tr_b16 v[34:35], v7 offset:1024
    v_mfma_f32_32x32x16_bf16 v[192:207], v[56:59], v[64:67], v[192:207]
    ds_read_b64_tr_b16 v[36:37], v8 offset:0
    ds_read_b64_tr_b16 v[38:39], v8 offset:1024
    v_mfma_f32_32x32x16_bf16 v[208:223], v[56:59], v[68:71], v[208:223]
    buffer_load_dwordx4 v74, s[12:15], s21 offen offset:2048 lds
    v_mfma_f32_32x32x16_bf16 v[224:239], v[60:63], v[64:67], v[224:239]
    v_mfma_f32_32x32x16_bf16 v[240:255], v[60:63], v[68:71], v[240:255]
    buffer_load_dwordx4 v75, s[12:15], s21 offen offset:3072 lds
    s_add_u32 s21, s21, 114688
    s_sub_u32 s25, s21, 1376256
    s_cmp_ge_u32 s21, s27
    s_cselect_b32 s21, s25, s21
    s_waitcnt lgkmcnt(0)
    v_mfma_f32_32x32x16_bf16 v[128:143], v[24:27], v[40:43], v[128:143]
    ds_read_b128 v[64:67], v17 offset:0
    ds_read_b64_tr_b16 v[48:49], v5 offset:4096
    v_mfma_f32_32x32x16_bf16 v[160:175], v[28:31], v[40:43], v[160:175]
    ds_read_b64_tr_b16 v[50:51], v5 offset:5120
    ds_read_b64_tr_b16 v[52:53], v6 offset:4096
    v_mfma_f32_32x32x16_bf16 v[144:159], v[24:27], v[44:47], v[144:159]
    ds_read_b64_tr_b16 v[54:55], v6 offset:5120
    ds_read_b128 v[68:71], v17 offset:4096
    v_mfma_f32_32x32x16_bf16 v[176:191], v[28:31], v[44:47], v[176:191]
    ds_read_b64_tr_b16 v[56:57], v7 offset:4096
    ds_read_b64_tr_b16 v[58:59], v7 offset:5120
    v_mfma_f32_32x32x16_bf16 v[192:207], v[32:35], v[40:43], v[192:207]
    ds_read_b64_tr_b16 v[60:61], v8 offset:4096
    ds_read_b64_tr_b16 v[62:63], v8 offset:5120
    v_mfma_f32_32x32x16_bf16 v[208:223], v[32:35], v[44:47], v[208:223]
    v_mfma_f32_32x32x16_bf16 v[224:239], v[36:39], v[40:43], v[224:239]
    v_mfma_f32_32x32x16_bf16 v[240:255], v[36:39], v[44:47], v[240:255]
    s_waitcnt lgkmcnt(0)
    s_waitcnt vmcnt(4)
    s_barrier
    v_mfma_f32_32x32x16_bf16 v[128:143], v[48:51], v[64:67], v[128:143]
    ds_read_b128 v[40:43], v14 offset:16384
    ds_read_b64_tr_b16 v[24:25], v5 offset:16384
    v_mfma_f32_32x32x16_bf16 v[160:175], v[52:55], v[64:67], v[160:175]
    s_add_u32 m0, s23, 0
    s_nop 0
    buffer_load_dwordx4 v72, s[12:15], s21 offen offset:0 lds
    ds_read_b64_tr_b16 v[26:27], v5 offset:17408
    ds_read_b64_tr_b16 v[28:29], v6 offset:16384
    v_mfma_f32_32x32x16_bf16 v[144:159], v[48:51], v[68:71], v[144:159]
    ds_read_b64_tr_b16 v[30:31], v6 offset:17408
    ds_read_b128 v[44:47], v14 offset:20480
    v_mfma_f32_32x32x16_bf16 v[176:191], v[52:55], v[68:71], v[176:191]
    buffer_load_dwordx4 v73, s[12:15], s21 offen offset:1024 lds
    ds_read_b64_tr_b16 v[32:33], v7 offset:16384
    ds_read_b64_tr_b16 v[34:35], v7 offset:17408
    v_mfma_f32_32x32x16_bf16 v[192:207], v[56:59], v[64:67], v[192:207]
    ds_read_b64_tr_b16 v[36:37], v8 offset:16384
    ds_read_b64_tr_b16 v[38:39], v8 offset:17408
    v_mfma_f32_32x32x16_bf16 v[208:223], v[56:59], v[68:71], v[208:223]
    buffer_load_dwordx4 v74, s[12:15], s21 offen offset:2048 lds
    v_mfma_f32_32x32x16_bf16 v[224:239], v[60:63], v[64:67], v[224:239]
    v_mfma_f32_32x32x16_bf16 v[240:255], v[60:63], v[68:71], v[240:255]
    buffer_load_dwordx4 v75, s[12:15], s21 offen offset:3072 lds
    s_add_u32 s21, s21, 114688
    s_sub_u32 s25, s21, 1376256
    s_cmp_ge_u32 s21, s27
    s_cselect_b32 s21, s25, s21
    s_waitcnt lgkmcnt(0)
    v_mfma_f32_32x32x16_bf16 v[128:143], v[24:27], v[40:43], v[128:143]
    ds_read_b128 v[64:67], v15 offset:16384
    ds_read_b64_tr_b16 v[48:49], v5 offset:20480
    v_mfma_f32_32x32x16_bf16 v[160:175], v[28:31], v[40:43], v[160:175]
    s_add_u32 m0, s22, 0
    s_nop 0
    buffer_load_dwordx4 v76, s[8:11], s20 offen offset:0 lds
    ds_read_b64_tr_b16 v[50:51], v5 offset:21504
    ds_read_b64_tr_b16 v[52:53], v6 offset:20480
    v_mfma_f32_32x32x16_bf16 v[144:159], v[24:27], v[44:47], v[144:159]
    ds_read_b64_tr_b16 v[54:55], v6 offset:21504
    ds_read_b128 v[68:71], v15 offset:20480
    v_mfma_f32_32x32x16_bf16 v[176:191], v[28:31], v[44:47], v[176:191]
    buffer_load_dwordx4 v77, s[8:11], s20 offen offset:1024 lds
    ds_read_b64_tr_b16 v[56:57], v7 offset:20480
    ds_read_b64_tr_b16 v[58:59], v7 offset:21504
    v_mfma_f32_32x32x16_bf16 v[192:207], v[32:35], v[40:43], v[192:207]
    ds_read_b64_tr_b16 v[60:61], v8 offset:20480
    ds_read_b64_tr_b16 v[62:63], v8 offset:21504
    v_mfma_f32_32x32x16_bf16 v[208:223], v[32:35], v[44:47], v[208:223]
    buffer_load_dwordx4 v78, s[8:11], s20 offen offset:2048 lds
    v_mfma_f32_32x32x16_bf16 v[224:239], v[36:39], v[40:43], v[224:239]
    v_mfma_f32_32x32x16_bf16 v[240:255], v[36:39], v[44:47], v[240:255]
    buffer_load_dwordx4 v79, s[8:11], s20 offen offset:3072 lds
    s_add_u32 s20, s20, 128
    s_sub_u32 s25, s20, 768
    s_cmp_ge_u32 s20, s26
    s_cselect_b32 s20, s25, s20
    s_waitcnt lgkmcnt(0)
    s_waitcnt vmcnt(8)
    s_barrier
    v_mfma_f32_32x32x16_bf16 v[128:143], v[48:51], v[64:67], v[128:143]
    ds_read_b128 v[40:43], v16 offset:16384
    ds_read_b64_tr_b16 v[24:25], v5 offset:32768
    v_mfma_f32_32x32x16_bf16 v[160:175], v[52:55], v[64:67], v[160:175]
    s_add_u32 m0, s23, 16384
    s_nop 0
    buffer_load_dwordx4 v72, s[12:15], s21 offen offset:0 lds
    ds_read_b64_tr_b16 v[26:27], v5 offset:33792
    ds_read_b64_tr_b16 v[28:29], v6 offset:32768
    v_mfma_f32_32x32x16_bf16 v[144:159], v[48:51], v[68:71], v[144:159]
    ds_read_b64_tr_b16 v[30:31], v6 offset:33792
    ds_read_b128 v[44:47], v16 offset:20480
    v_mfma_f32_32x32x16_bf16 v[176:191], v[52:55], v[68:71], v[176:191]
    buffer_load_dwordx4 v73, s[12:15], s21 offen offset:1024 lds
    ds_read_b64_tr_b16 v[32:33], v7 offset:32768
    ds_read_b64_tr_b16 v[34:35], v7 offset:33792
    v_mfma_f32_32x32x16_bf16 v[192:207], v[56:59], v[64:67], v[192:207]
    ds_read_b64_tr_b16 v[36:37], v8 offset:32768
    ds_read_b64_tr_b16 v[38:39], v8 offset:33792
    v_mfma_f32_32x32x16_bf16 v[208:223], v[56:59], v[68:71], v[208:223]
    buffer_load_dwordx4 v74, s[12:15], s21 offen offset:2048 lds
    v_mfma_f32_32x32x16_bf16 v[224:239], v[60:63], v[64:67], v[224:239]
    v_mfma_f32_32x32x16_bf16 v[240:255], v[60:63], v[68:71], v[240:255]
    buffer_load_dwordx4 v75, s[12:15], s21 offen offset:3072 lds
    s_add_u32 s21, s21, 114688
    s_sub_u32 s25, s21, 1376256
    s_cmp_ge_u32 s21, s27
    s_cselect_b32 s21, s25, s21
    s_waitcnt lgkmcnt(0)
    v_mfma_f32_32x32x16_bf16 v[128:143], v[24:27], v[40:43], v[128:143]
    ds_read_b128 v[64:67], v17 offset:16384
    ds_read_b64_tr_b16 v[48:49], v5 offset:36864
    v_mfma_f32_32x32x16_bf16 v[160:175], v[28:31], v[40:43], v[160:175]
    ds_read_b64_tr_b16 v[50:51], v5 offset:37888
    ds_read_b64_tr_b16 v[52:53], v6 offset:36864
    v_mfma_f32_32x32x16_bf16 v[144:159], v[24:27], v[44:47], v[144:159]
    ds_read_b64_tr_b16 v[54:55], v6 offset:37888
    ds_read_b128 v[68:71], v17 offset:20480
    v_mfma_f32_32x32x16_bf16 v[176:191], v[28:31], v[44:47], v[176:191]
    ds_read_b64_tr_b16 v[56:57], v7 offset:36864
    ds_read_b64_tr_b16 v[58:59], v7 offset:37888
    v_mfma_f32_32x32x16_bf16 v[192:207], v[32:35], v[40:43], v[192:207]
    ds_read_b64_tr_b16 v[60:61], v8 offset:36864
    ds_read_b64_tr_b16 v[62:63], v8 offset:37888
    v_mfma_f32_32x32x16_bf16 v[208:223], v[32:35], v[44:47], v[208:223]
    v_mfma_f32_32x32x16_bf16 v[224:239], v[36:39], v[40:43], v[224:239]
    v_mfma_f32_32x32x16_bf16 v[240:255], v[36:39], v[44:47], v[240:255]
    s_waitcnt lgkmcnt(0)
    s_waitcnt vmcnt(4)
    s_barrier
    v_readfirstlane_b32 s37, v23
    s_nop 3
    s_cmp_lg_u32 s37, 0
    s_cbranch_scc1 g1_mf_fast
    v_mov_b32 v21, 0
    s_mov_b32 s25, 0
g1_wr:
    global_load_dword v23, v21, s[28:29] sc1
    s_waitcnt vmcnt(0)
    v_readfirstlane_b32 s37, v23
    s_add_u32 s25, s25, 1
    s_cmp_ge_u32 s25, 400000
    s_cbranch_scc1 g1_wr_ok
    s_cmp_lg_u32 s37, 0
    s_cbranch_scc1 g1_wr_ok
    s_sleep 8
    s_branch g1_wr
g1_wr_ok:
    v_mov_b32 v21, 0
g1_mf_fast:
    v_mov_b32 v22, s37
    s_mov_b64 exec, 1
    buffer_store_dword v22, v21, s[52:55], s56 offen sc1
    s_mov_b64 exec, -1
    v_mfma_f32_32x32x16_bf16 v[128:143], v[48:51], v[64:67], v[128:143]
    ds_read_b128 v[40:43], v14 offset:0
    ds_read_b64_tr_b16 v[24:25], v5 offset:0
    v_mfma_f32_32x32x16_bf16 v[160:175], v[52:55], v[64:67], v[160:175]
    s_add_u32 m0, s98, 32768
    s_nop 0
    buffer_load_dwordx4 v20, s[92:95], s96 offen lds
    ds_read_b64_tr_b16 v[26:27], v5 offset:1024
    ds_read_b64_tr_b16 v[28:29], v6 offset:0
    v_mfma_f32_32x32x16_bf16 v[144:159], v[48:51], v[68:71], v[144:159]
    ds_read_b64_tr_b16 v[30:31], v6 offset:1024
    ds_read_b128 v[44:47], v14 offset:4096
    v_mfma_f32_32x32x16_bf16 v[176:191], v[52:55], v[68:71], v[176:191]
    buffer_load_dwordx4 v19, s[92:95], s96 offen offset:1024 lds
    s_add_u32 s96, s96, 57344
    s_sub_u32 s99, s96, 802816
    s_cmp_ge_u32 s96, s97
    s_cselect_b32 s96, s99, s96
    ds_read_b64_tr_b16 v[32:33], v7 offset:0
    ds_read_b64_tr_b16 v[34:35], v7 offset:1024
    v_mfma_f32_32x32x16_bf16 v[192:207], v[56:59], v[64:67], v[192:207]
    ds_read_b64_tr_b16 v[36:37], v8 offset:0
    ds_read_b64_tr_b16 v[38:39], v8 offset:1024
    v_mfma_f32_32x32x16_bf16 v[208:223], v[56:59], v[68:71], v[208:223]
    s_add_u32 m0, s98, 40960
    s_nop 0
    buffer_load_dwordx4 v20, s[92:95], s96 offen lds
    v_mfma_f32_32x32x16_bf16 v[224:239], v[60:63], v[64:67], v[224:239]
    v_mfma_f32_32x32x16_bf16 v[240:255], v[60:63], v[68:71], v[240:255]
    buffer_load_dwordx4 v19, s[92:95], s96 offen offset:1024 lds
    s_add_u32 s96, s96, 57344
    s_sub_u32 s99, s96, 802816
    s_cmp_ge_u32 s96, s97
    s_cselect_b32 s96, s99, s96
    s_waitcnt lgkmcnt(0)
    v_mfma_f32_32x32x16_bf16 v[128:143], v[24:27], v[40:43], v[128:143]
    ds_read_b128 v[64:67], v15 offset:0
    ds_read_b64_tr_b16 v[48:49], v5 offset:4096
    v_mfma_f32_32x32x16_bf16 v[160:175], v[28:31], v[40:43], v[160:175]
    s_add_u32 m0, s98, 65536
    s_nop 0
    buffer_load_dwordx4 v20, s[92:95], s96 offen lds
    ds_read_b64_tr_b16 v[50:51], v5 offset:5120
    ds_read_b64_tr_b16 v[52:53], v6 offset:4096
    v_mfma_f32_32x32x16_bf16 v[144:159], v[24:27], v[44:47], v[144:159]
    ds_read_b64_tr_b16 v[54:55], v6 offset:5120
    ds_read_b128 v[68:71], v15 offset:4096
    v_mfma_f32_32x32x16_bf16 v[176:191], v[28:31], v[44:47], v[176:191]
    buffer_load_dwordx4 v19, s[92:95], s96 offen offset:1024 lds
    s_add_u32 s96, s96, 57344
    s_sub_u32 s99, s96, 802816
    s_cmp_ge_u32 s96, s97
    s_cselect_b32 s96, s99, s96
    ds_read_b64_tr_b16 v[56:57], v7 offset:4096
    ds_read_b64_tr_b16 v[58:59], v7 offset:5120
    v_mfma_f32_32x32x16_bf16 v[192:207], v[32:35], v[40:43], v[192:207]
    ds_read_b64_tr_b16 v[60:61], v8 offset:4096
    ds_read_b64_tr_b16 v[62:63], v8 offset:5120
    v_mfma_f32_32x32x16_bf16 v[208:223], v[32:35], v[44:47], v[208:223]
    s_add_u32 m0, s98, 73728
    s_nop 0
    buffer_load_dwordx4 v20, s[92:95], s96 offen lds
    v_mfma_f32_32x32x16_bf16 v[224:239], v[36:39], v[40:43], v[224:239]
    v_mfma_f32_32x32x16_bf16 v[240:255], v[36:39], v[44:47], v[240:255]
    buffer_load_dwordx4 v19, s[92:95], s96 offen offset:1024 lds
    s_add_u32 s96, s96, 57344
    s_sub_u32 s99, s96, 802816
    s_cmp_ge_u32 s96, s97
    s_cselect_b32 s96, s99, s96
    s_waitcnt lgkmcnt(0)
    s_waitcnt vmcnt(9)
    s_barrier
    v_mfma_f32_32x32x16_bf16 v[128:143], v[48:51], v[64:67], v[128:143]
    ds_read_b128 v[40:43], v16 offset:0
    ds_read_b64_tr_b16 v[24:25], v5 offset:16384
    v_mfma_f32_32x32x16_bf16 v[160:175], v[52:55], v[64:67], v[160:175]
    ds_read_b64_tr_b16 v[26:27], v5 offset:17408
    ds_read_b64_tr_b16 v[28:29], v6 offset:16384
    v_mfma_f32_32x32x16_bf16 v[144:159], v[48:51], v[68:71], v[144:159]
    ds_read_b64_tr_b16 v[30:31], v6 offset:17408
    ds_read_b128 v[44:47], v16 offset:4096
    v_mfma_f32_32x32x16_bf16 v[176:191], v[52:55], v[68:71], v[176:191]
    ds_read_b64_tr_b16 v[32:33], v7 offset:16384
    ds_read_b64_tr_b16 v[34:35], v7 offset:17408
    v_mfma_f32_32x32x16_bf16 v[192:207], v[56:59], v[64:67], v[192:207]
    ds_read_b64_tr_b16 v[36:37], v8 offset:16384
    ds_read_b64_tr_b16 v[38:39], v8 offset:17408
    v_mfma_f32_32x32x16_bf16 v[208:223], v[56:59], v[68:71], v[208:223]
    v_mfma_f32_32x32x16_bf16 v[224:239], v[60:63], v[64:67], v[224:239]
    v_mfma_f32_32x32x16_bf16 v[240:255], v[60:63], v[68:71], v[240:255]
    s_waitcnt lgkmcnt(0)
    v_mfma_f32_32x32x16_bf16 v[128:143], v[24:27], v[40:43], v[128:143]
    ds_read_b128 v[64:67], v17 offset:0
    ds_read_b64_tr_b16 v[48:49], v5 offset:20480
    v_mfma_f32_32x32x16_bf16 v[160:175], v[28:31], v[40:43], v[160:175]
    ds_read_b64_tr_b16 v[50:51], v5 offset:21504
    ds_read_b64_tr_b16 v[52:53], v6 offset:20480
    v_mfma_f32_32x32x16_bf16 v[144:159], v[24:27], v[44:47], v[144:159]
    ds_read_b64_tr_b16 v[54:55], v6 offset:21504
    ds_read_b128 v[68:71], v17 offset:4096
    v_mfma_f32_32x32x16_bf16 v[176:191], v[28:31], v[44:47], v[176:191]
    ds_read_b64_tr_b16 v[56:57], v7 offset:20480
    ds_read_b64_tr_b16 v[58:59], v7 offset:21504
    v_mfma_f32_32x32x16_bf16 v[192:207], v[32:35], v[40:43], v[192:207]
    ds_read_b64_tr_b16 v[60:61], v8 offset:20480
    ds_read_b64_tr_b16 v[62:63], v8 offset:21504
    v_mfma_f32_32x32x16_bf16 v[208:223], v[32:35], v[44:47], v[208:223]
    v_mfma_f32_32x32x16_bf16 v[224:239], v[36:39], v[40:43], v[224:239]
    v_mfma_f32_32x32x16_bf16 v[240:255], v[36:39], v[44:47], v[240:255]
    s_waitcnt lgkmcnt(0)
    s_barrier
    v_mfma_f32_32x32x16_bf16 v[128:143], v[48:51], v[64:67], v[128:143]
    v_mfma_f32_32x32x16_bf16 v[160:175], v[52:55], v[64:67], v[160:175]
    s_add_u32 m0, s98, 49152
    s_nop 0
    buffer_load_dwordx4 v20, s[92:95], s96 offen lds
    v_mfma_f32_32x32x16_bf16 v[144:159], v[48:51], v[68:71], v[144:159]
    v_mfma_f32_32x32x16_bf16 v[176:191], v[52:55], v[68:71], v[176:191]
    buffer_load_dwordx4 v19, s[92:95], s96 offen offset:1024 lds
    s_add_u32 s96, s96, 57344
    s_sub_u32 s99, s96, 802816
    s_cmp_ge_u32 s96, s97
    s_cselect_b32 s96, s99, s96
    v_mfma_f32_32x32x16_bf16 v[192:207], v[56:59], v[64:67], v[192:207]
    v_mfma_f32_32x32x16_bf16 v[208:223], v[56:59], v[68:71], v[208:223]
    s_add_u32 m0, s98, 57344
    s_nop 0
    buffer_load_dwordx4 v20, s[92:95], s96 offen lds
    v_mfma_f32_32x32x16_bf16 v[224:239], v[60:63], v[64:67], v[224:239]
    v_mfma_f32_32x32x16_bf16 v[240:255], v[60:63], v[68:71], v[240:255]
    buffer_load_dwordx4 v19, s[92:95], s96 offen offset:1024 lds
    s_add_u32 s96, s96, 57344
    s_sub_u32 s99, s96, 802816
    s_cmp_ge_u32 s96, s97
    s_cselect_b32 s96, s99, s96
    s_mov_b32 s36, 0xffff0000
    s_nop 7
    v_mul_f32 v34, v128, v136
    v_mul_f32 v35, v129, v137
    v_cvt_pk_bf16_f32 v24, v34, v35
    v_mul_f32 v34, v130, v138
    v_mul_f32 v35, v131, v139
    v_cvt_pk_bf16_f32 v25, v34, v35
    v_mul_f32 v34, v132, v140
    v_mul_f32 v35, v133, v141
    v_cvt_pk_bf16_f32 v26, v34, v35
    v_mul_f32 v34, v134, v142
    v_mul_f32 v35, v135, v143
    v_cvt_pk_bf16_f32 v27, v34, v35
    ds_write_b128 v91, v[24:27] offset:0
    v_mul_f32 v34, v160, v168
    v_mul_f32 v35, v161, v169
    v_cvt_pk_bf16_f32 v28, v34, v35
    v_mul_f32 v34, v162, v170
    v_mul_f32 v35, v163, v171
    v_cvt_pk_bf16_f32 v29, v34, v35
    v_mul_f32 v34, v164, v172
    v_mul_f32 v35, v165, v173
    v_cvt_pk_bf16_f32 v30, v34, v35
    v_mul_f32 v34, v166, v174
    v_mul_f32 v35, v167, v175
    v_cvt_pk_bf16_f32 v31, v34, v35
    ds_write_b128 v92, v[28:31] offset:0
    v_mul_f32 v34, v192, v200
    v_mul_f32 v35, v193, v201
    v_cvt_pk_bf16_f32 v24, v34, v35
    v_mul_f32 v34, v194, v202
    v_mul_f32 v35, v195, v203
    v_cvt_pk_bf16_f32 v25, v34, v35
    v_mul_f32 v34, v196, v204
    v_mul_f32 v35, v197, v205
    v_cvt_pk_bf16_f32 v26, v34, v35
    v_mul_f32 v34, v198, v206
    v_mul_f32 v35, v199, v207
    v_cvt_pk_bf16_f32 v27, v34, v35
    ds_write_b128 v93, v[24:27] offset:0
    v_mul_f32 v34, v224, v232
    v_mul_f32 v35, v225, v233
    v_cvt_pk_bf16_f32 v28, v34, v35
    v_mul_f32 v34, v226, v234
    v_mul_f32 v35, v227, v235
    v_cvt_pk_bf16_f32 v29, v34, v35
    v_mul_f32 v34, v228, v236
    v_mul_f32 v35, v229, v237
    v_cvt_pk_bf16_f32 v30, v34, v35
    v_mul_f32 v34, v230, v238
    v_mul_f32 v35, v231, v239
    v_cvt_pk_bf16_f32 v31, v34, v35
    ds_write_b128 v94, v[28:31] offset:0
    ds_read_b128 v[40:43], v96 offset:0
    ds_read_b128 v[44:47], v96 offset:1024
    ds_read_b128 v[48:51], v96 offset:2048
    ds_read_b128 v[52:55], v96 offset:3072
    v_mul_f32 v34, v144, v152
    v_mul_f32 v35, v145, v153
    v_cvt_pk_bf16_f32 v24, v34, v35
    v_mul_f32 v34, v146, v154
    v_mul_f32 v35, v147, v155
    v_cvt_pk_bf16_f32 v25, v34, v35
    v_mul_f32 v34, v148, v156
    v_mul_f32 v35, v149, v157
    v_cvt_pk_bf16_f32 v26, v34, v35
    v_mul_f32 v34, v150, v158
    v_mul_f32 v35, v151, v159
    v_cvt_pk_bf16_f32 v27, v34, v35
    ds_write_b128 v91, v[24:27] offset:4096
    v_mul_f32 v34, v176, v184
    v_mul_f32 v35, v177, v185
    v_cvt_pk_bf16_f32 v28, v34, v35
    v_mul_f32 v34, v178, v186
    v_mul_f32 v35, v179, v187
    v_cvt_pk_bf16_f32 v29, v34, v35
    v_mul_f32 v34, v180, v188
    v_mul_f32 v35, v181, v189
    v_cvt_pk_bf16_f32 v30, v34, v35
    v_mul_f32 v34, v182, v190
    v_mul_f32 v35, v183, v191
    v_cvt_pk_bf16_f32 v31, v34, v35
    ds_write_b128 v92, v[28:31] offset:4096
    v_mul_f32 v34, v208, v216
    v_mul_f32 v35, v209, v217
    v_cvt_pk_bf16_f32 v24, v34, v35
    v_mul_f32 v34, v210, v218
    v_mul_f32 v35, v211, v219
    v_cvt_pk_bf16_f32 v25, v34, v35
    v_mul_f32 v34, v212, v220
    v_mul_f32 v35, v213, v221
    v_cvt_pk_bf16_f32 v26, v34, v35
    v_mul_f32 v34, v214, v222
    v_mul_f32 v35, v215, v223
    v_cvt_pk_bf16_f32 v27, v34, v35
    ds_write_b128 v93, v[24:27] offset:4096
    v_mul_f32 v34, v240, v248
    v_mul_f32 v35, v241, v249
    v_cvt_pk_bf16_f32 v28, v34, v35
    v_mul_f32 v34, v242, v250
    v_mul_f32 v35, v243, v251
    v_cvt_pk_bf16_f32 v29, v34, v35
    v_mul_f32 v34, v244, v252
    v_mul_f32 v35, v245, v253
    v_cvt_pk_bf16_f32 v30, v34, v35
    v_mul_f32 v34, v246, v254
    v_mul_f32 v35, v247, v255
    v_cvt_pk_bf16_f32 v31, v34, v35
    ds_write_b128 v94, v[28:31] offset:4096
    ds_read_b128 v[56:59], v96 offset:4096
    ds_read_b128 v[60:63], v96 offset:5120
    ds_read_b128 v[64:67], v96 offset:6144
    ds_read_b128 v[68:71], v96 offset:7168
    s_waitcnt lgkmcnt(11)
    s_add_u32 s24, s30, 0
    buffer_store_dwordx4 v[40:43], v95, s[16:19], s24 offen sc1
    s_waitcnt lgkmcnt(10)
    s_add_u32 s24, s30, 28672
    buffer_store_dwordx4 v[44:47], v95, s[16:19], s24 offen sc1
    s_waitcnt lgkmcnt(9)
    s_add_u32 s24, s30, 57344
    buffer_store_dwordx4 v[48:51], v95, s[16:19], s24 offen sc1
    s_waitcnt lgkmcnt(8)
    s_add_u32 s24, s30, 86016
    buffer_store_dwordx4 v[52:55], v95, s[16:19], s24 offen sc1
    s_waitcnt lgkmcnt(3)
    s_add_u32 s24, s30, 114688
    buffer_store_dwordx4 v[56:59], v95, s[16:19], s24 offen sc1
    s_waitcnt lgkmcnt(2)
    s_add_u32 s24, s30, 143360
    buffer_store_dwordx4 v[60:63], v95, s[16:19], s24 offen sc1
    s_waitcnt lgkmcnt(1)
    s_add_u32 s24, s30, 172032
    buffer_store_dwordx4 v[64:67], v95, s[16:19], s24 offen sc1
    s_waitcnt lgkmcnt(0)
    s_add_u32 s24, s30, 200704
    buffer_store_dwordx4 v[68:71], v95, s[16:19], s24 offen sc1
    s_barrier
    s_add_u32 m0, s98, 0
    s_nop 0
    buffer_load_dwordx4 v20, s[92:95], s96 offen lds
    buffer_load_dwordx4 v19, s[92:95], s96 offen offset:1024 lds
    s_add_u32 s96, s96, 57344
    s_sub_u32 s99, s96, 802816
    s_cmp_ge_u32 s96, s97
    s_cselect_b32 s96, s99, s96
    s_add_u32 m0, s98, 8192
    s_nop 0
    buffer_load_dwordx4 v20, s[92:95], s96 offen lds
    buffer_load_dwordx4 v19, s[92:95], s96 offen offset:1024 lds
    s_add_u32 s96, s96, 57344
    s_sub_u32 s99, s96, 802816
    s_cmp_ge_u32 s96, s97
    s_cselect_b32 s96, s99, s96
    s_add_u32 m0, s98, 16384
    s_nop 0
    buffer_load_dwordx4 v20, s[92:95], s96 offen lds
    buffer_load_dwordx4 v19, s[92:95], s96 offen offset:1024 lds
    s_add_u32 s96, s96, 57344
    s_sub_u32 s99, s96, 802816
    s_cmp_ge_u32 s96, s97
    s_cselect_b32 s96, s99, s96
    s_add_u32 m0, s98, 24576
    s_nop 0
    buffer_load_dwordx4 v20, s[92:95], s96 offen lds
    buffer_load_dwordx4 v19, s[92:95], s96 offen offset:1024 lds
    s_add_u32 s96, s96, 57344
    s_sub_u32 s99, s96, 802816
    s_cmp_ge_u32 s96, s97
    s_cselect_b32 s96, s99, s96
    s_lshr_b32 s24, s5, 7
    s_mul_i32 s57, s24, 1792
    s_lshr_b32 s25, s6, 5
    s_add_u32 s57, s57, s25
    s_mov_b32 s58, 1
    s_branch f_g2
f_aux:
    s_lshl_b32 s48, s40, 2
    s_add_u32 s48, s48, s41
    s_lshl_b32 s5, s48, 6
    s_load_dwordx2 s[28:29], s[0:1], 0
    s_load_dwordx2 s[30:31], s[0:1], 128
    s_load_dwordx2 s[32:33], s[0:1], 104
    s_load_dwordx2 s[34:35], s[0:1], 120
    v_lshrrev_b32 v10, 4, v0
    v_lshrrev_b32 v11, 3, v0
    v_mul_u32_u24 v11, 896, v11
    v_and_b32 v12, 7, v0
    v_xor_b32 v13, v12, v10
    v_lshlrev_b32 v13, 4, v13
    v_add_u32 v2, v11, v13
    v_xor_b32 v13, 64, v13
    v_add_u32 v3, v11, v13
    v_add_u32 v3, 6144, v3
    v_lshlrev_b32 v4, 4, v0
    s_lshl_b32 s24, s4, 4
    s_add_u32 s25, s5, s24
    s_mul_i32 s26, s25, 896
    s_lshl_b32 s27, s4, 11
    s_waitcnt lgkmcnt(0)
    s_mov_b32 s8, s28
    s_mov_b32 s9, s29
    s_mov_b32 s10, 1835008
    s_mov_b32 s11, 0x20000
    s_mov_b32 s12, s32
    s_mov_b32 s13, s33
    s_mov_b32 s14, 896
    s_mov_b32 s15, 0x20000
    s_add_u32 m0, s27, 0
    s_add_u32 s24, s26, 0
    buffer_load_dwordx4 v2, s[8:11], s24 offen lds
    buffer_load_dwordx4 v3, s[8:11], s24 offen offset:1024 lds
    s_add_u32 m0, s27, 8192
    s_add_u32 s24, s26, 128
    buffer_load_dwordx4 v2, s[8:11], s24 offen lds
    buffer_load_dwordx4 v3, s[8:11], s24 offen offset:1024 lds
    s_add_u32 m0, s27, 16384
    s_add_u32 s24, s26, 256
    buffer_load_dwordx4 v2, s[8:11], s24 offen lds
    buffer_load_dwordx4 v3, s[8:11], s24 offen offset:1024 lds
    s_add_u32 m0, s27, 24576
    s_add_u32 s24, s26, 384
    buffer_load_dwordx4 v2, s[8:11], s24 offen lds
    buffer_load_dwordx4 v3, s[8:11], s24 offen offset:1024 lds
    s_add_u32 m0, s27, 32768
    s_add_u32 s24, s26, 512
    buffer_load_dwordx4 v2, s[8:11], s24 offen lds
    buffer_load_dwordx4 v3, s[8:11], s24 offen offset:1024 lds
    s_add_u32 m0, s27, 40960
    s_add_u32 s24, s26, 640
    buffer_load_dwordx4 v2, s[8:11], s24 offen lds
    buffer_load_dwordx4 v3, s[8:11], s24 offen offset:1024 lds
    s_add_u32 m0, s27, 49152
    s_add_u32 s24, s26, 768
    buffer_load_dwordx4 v2, s[8:11], s24 offen lds
    buffer_load_dwordx4 v3, s[8:11], s24 offen offset:1024 lds
    s_lshl_b32 s24, s4, 10
    s_add_u32 m0, s24, 57344
    s_nop 0
    buffer_load_dwordx4 v4, s[12:15], 0 offen lds
    v_lshrrev_b32 v10, 2, v0
    s_lshl_b32 s26, s4, 4
    v_add_u32 v10, s26, v10
    v_lshrrev_b32 v11, 1, v10
    v_and_b32 v11, 7, v11
    v_and_b32 v12, 3, v0
    v_lshlrev_b32 v14, 1, v12
    v_xor_b32 v14, v14, v11
    v_lshlrev_b32 v13, 7, v10
    v_lshlrev_b32 v14, 4, v14
    v_add_u32 v18, v13, v14
    v_xor_b32 v14, 16, v14
    v_add_u32 v19, v13, v14
    v_lshlrev_b32 v17, 5, v12
    s_add_u32 s24, s24, 57344
    v_add_u32 v17, s24, v17
    s_load_dwordx2 s[44:45], s[0:1], 96
    s_lshl_b32 s58, s48, 2
    s_add_u32 s58, s58, s4
    s_mul_i32 s58, s58, 13312
    v_lshlrev_b32 v60, 4, v0
    s_waitcnt lgkmcnt(0)
    s_mov_b32 s46, 1605632
    s_mov_b32 s47, 0x20000
    buffer_load_dwordx4 v[200:203], v60, s[44:47], s58 offen
    s_add_u32 s58, s58, 1024
    buffer_load_dwordx4 v[204:207], v60, s[44:47], s58 offen
    s_add_u32 s58, s58, 1024
    buffer_load_dwordx4 v[208:211], v60, s[44:47], s58 offen
    s_add_u32 s58, s58, 1024
    buffer_load_dwordx4 v[212:215], v60, s[44:47], s58 offen
    s_add_u32 s58, s58, 1024
    buffer_load_dwordx4 v[216:219], v60, s[44:47], s58 offen
    s_add_u32 s58, s58, 1024
    buffer_load_dwordx4 v[220:223], v60, s[44:47], s58 offen
    s_add_u32 s58, s58, 1024
    buffer_load_dwordx4 v[224:227], v60, s[44:47], s58 offen
    s_add_u32 s58, s58, 1024
    buffer_load_dwordx4 v[228:231], v60, s[44:47], s58 offen
    s_add_u32 s58, s58, 1024
    buffer_load_dwordx4 v[200:203], v60, s[44:47], s58 offen
    s_add_u32 s58, s58, 1024
    buffer_load_dwordx4 v[204:207], v60, s[44:47], s58 offen
    s_add_u32 s58, s58, 1024
    buffer_load_dwordx4 v[208:211], v60, s[44:47], s58 offen
    s_add_u32 s58, s58, 1024
    buffer_load_dwordx4 v[212:215], v60, s[44:47], s58 offen
    s_add_u32 s58, s58, 1024
    buffer_load_dwordx4 v[216:219], v60, s[44:47], s58 offen
    s_add_u32 s58, s58, 1024
    s_add_u32 s20, s30, 14811136
    s_addc_u32 s21, s31, 0
    s_mov_b32 s22, 8192
    s_mov_b32 s23, 0x20000
    s_add_u32 s52, s30, 14876672
    s_addc_u32 s53, s31, 0
    s_mov_b32 s54, 114688
    s_mov_b32 s55, 0x20000
    s_cmp_lg_u32 s4, 0
    s_cbranch_scc1 aux_mf_done
    v_mov_b32 v10, 0
    s_mov_b32 s25, 0
aux_wr:
    global_load_dword v11, v10, s[34:35] sc1
    s_waitcnt vmcnt(0)
    v_readfirstlane_b32 s37, v11
    s_add_u32 s25, s25, 1
    s_cmp_ge_u32 s25, 400000
    s_cbranch_scc1 aux_wr_ok
    s_cmp_lg_u32 s37, 0
    s_cbranch_scc1 aux_wr_ok
    s_sleep 8
    s_branch aux_wr
aux_wr_ok:
    s_sub_u32 s25, s41, 4
    s_cmp_ge_u32 s25, 28
    s_cbranch_scc1 aux_mf_done
    s_lshl_b32 s24, s25, 3
    s_add_u32 s24, s24, s40
    s_add_u32 s24, s24, 672
    s_lshl_b32 s24, s24, 7
    v_mov_b32 v10, 0
    v_mov_b32 v11, s37
    s_mov_b64 exec, 0x1
    buffer_store_dword v11, v10, s[52:55], s24 offen sc1
    s_mov_b64 exec, -1
aux_mf_done:
    s_waitcnt vmcnt(0)
    ds_read_b128 v[120:123], v18 offset:0
    ds_read_b128 v[124:127], v19 offset:0
    ds_read_b128 v[64:67], v17 offset:0
    ds_read_b128 v[68:71], v17 offset:16
    ds_read_b128 v[128:131], v18 offset:8192
    ds_read_b128 v[132:135], v19 offset:8192
    ds_read_b128 v[72:75], v17 offset:128
    ds_read_b128 v[76:79], v17 offset:144
    ds_read_b128 v[136:139], v18 offset:16384
    ds_read_b128 v[140:143], v19 offset:16384
    ds_read_b128 v[80:83], v17 offset:256
    ds_read_b128 v[84:87], v17 offset:272
    ds_read_b128 v[144:147], v18 offset:24576
    ds_read_b128 v[148:151], v19 offset:24576
    ds_read_b128 v[88:91], v17 offset:384
    ds_read_b128 v[92:95], v17 offset:400
    ds_read_b128 v[152:155], v18 offset:32768
    ds_read_b128 v[156:159], v19 offset:32768
    ds_read_b128 v[96:99], v17 offset:512
    ds_read_b128 v[100:103], v17 offset:528
    ds_read_b128 v[160:163], v18 offset:40960
    ds_read_b128 v[164:167], v19 offset:40960
    ds_read_b128 v[104:107], v17 offset:640
    ds_read_b128 v[108:111], v17 offset:656
    ds_read_b128 v[168:171], v18 offset:49152
    ds_read_b128 v[172:175], v19 offset:49152
    ds_read_b128 v[112:115], v17 offset:768
    ds_read_b128 v[116:119], v17 offset:784
    s_waitcnt lgkmcnt(0)
    v_mov_b32 v20, 0
    v_mov_b32 v21, 0
    s_mov_b32 s36, 0xffff0000
    v_lshlrev_b32 v22, 16, v120
    v_and_b32 v120, s36, v120
    v_lshlrev_b32 v23, 16, v64
    v_and_b32 v64, s36, v64
    v_mul_f32 v22, v22, v23
    v_mul_f32 v120, v120, v64
    v_cvt_pk_bf16_f32 v22, v22, v120
    v_lshlrev_b32 v23, 16, v22
    v_and_b32 v22, s36, v22
    v_add_f32 v20, v20, v23
    v_add_f32 v20, v20, v22
    v_lshlrev_b32 v22, 16, v121
    v_and_b32 v121, s36, v121
    v_lshlrev_b32 v23, 16, v65
    v_and_b32 v65, s36, v65
    v_mul_f32 v22, v22, v23
    v_mul_f32 v121, v121, v65
    v_cvt_pk_bf16_f32 v22, v22, v121
    v_lshlrev_b32 v23, 16, v22
    v_and_b32 v22, s36, v22
    v_add_f32 v20, v20, v23
    v_add_f32 v20, v20, v22
    v_lshlrev_b32 v22, 16, v122
    v_and_b32 v122, s36, v122
    v_lshlrev_b32 v23, 16, v66
    v_and_b32 v66, s36, v66
    v_mul_f32 v22, v22, v23
    v_mul_f32 v122, v122, v66
    v_cvt_pk_bf16_f32 v22, v22, v122
    v_lshlrev_b32 v23, 16, v22
    v_and_b32 v22, s36, v22
    v_add_f32 v20, v20, v23
    v_add_f32 v20, v20, v22
    v_lshlrev_b32 v22, 16, v123
    v_and_b32 v123, s36, v123
    v_lshlrev_b32 v23, 16, v67
    v_and_b32 v67, s36, v67
    v_mul_f32 v22, v22, v23
    v_mul_f32 v123, v123, v67
    v_cvt_pk_bf16_f32 v22, v22, v123
    v_lshlrev_b32 v23, 16, v22
    v_and_b32 v22, s36, v22
    v_add_f32 v20, v20, v23
    v_add_f32 v20, v20, v22
    v_lshlrev_b32 v22, 16, v124
    v_and_b32 v124, s36, v124
    v_lshlrev_b32 v23, 16, v68
    v_and_b32 v68, s36, v68
    v_mul_f32 v22, v22, v23
    v_mul_f32 v124, v124, v68
    v_cvt_pk_bf16_f32 v22, v22, v124
    v_lshlrev_b32 v23, 16, v22
    v_and_b32 v22, s36, v22
    v_add_f32 v20, v20, v23
    v_add_f32 v20, v20, v22
    v_lshlrev_b32 v22, 16, v125
    v_and_b32 v125, s36, v125
    v_lshlrev_b32 v23, 16, v69
    v_and_b32 v69, s36, v69
    v_mul_f32 v22, v22, v23
    v_mul_f32 v125, v125, v69
    v_cvt_pk_bf16_f32 v22, v22, v125
    v_lshlrev_b32 v23, 16, v22
    v_and_b32 v22, s36, v22
    v_add_f32 v20, v20, v23
    v_add_f32 v20, v20, v22
    v_lshlrev_b32 v22, 16, v126
    v_and_b32 v126, s36, v126
    v_lshlrev_b32 v23, 16, v70
    v_and_b32 v70, s36, v70
    v_mul_f32 v22, v22, v23
    v_mul_f32 v126, v126, v70
    v_cvt_pk_bf16_f32 v22, v22, v126
    v_lshlrev_b32 v23, 16, v22
    v_and_b32 v22, s36, v22
    v_add_f32 v20, v20, v23
    v_add_f32 v20, v20, v22
    v_lshlrev_b32 v22, 16, v127
    v_and_b32 v127, s36, v127
    v_lshlrev_b32 v23, 16, v71
    v_and_b32 v71, s36, v71
    v_mul_f32 v22, v22, v23
    v_mul_f32 v127, v127, v71
    v_cvt_pk_bf16_f32 v22, v22, v127
    v_lshlrev_b32 v23, 16, v22
    v_and_b32 v22, s36, v22
    v_add_f32 v20, v20, v23
    v_add_f32 v20, v20, v22
    v_lshlrev_b32 v22, 16, v128
    v_and_b32 v128, s36, v128
    v_lshlrev_b32 v23, 16, v72
    v_and_b32 v72, s36, v72
    v_mul_f32 v22, v22, v23
    v_mul_f32 v128, v128, v72
    v_cvt_pk_bf16_f32 v22, v22, v128
    v_lshlrev_b32 v23, 16, v22
    v_and_b32 v22, s36, v22
    v_add_f32 v20, v20, v23
    v_add_f32 v20, v20, v22
    v_lshlrev_b32 v22, 16, v129
    v_and_b32 v129, s36, v129
    v_lshlrev_b32 v23, 16, v73
    v_and_b32 v73, s36, v73
    v_mul_f32 v22, v22, v23
    v_mul_f32 v129, v129, v73
    v_cvt_pk_bf16_f32 v22, v22, v129
    v_lshlrev_b32 v23, 16, v22
    v_and_b32 v22, s36, v22
    v_add_f32 v20, v20, v23
    v_add_f32 v20, v20, v22
    v_lshlrev_b32 v22, 16, v130
    v_and_b32 v130, s36, v130
    v_lshlrev_b32 v23, 16, v74
    v_and_b32 v74, s36, v74
    v_mul_f32 v22, v22, v23
    v_mul_f32 v130, v130, v74
    v_cvt_pk_bf16_f32 v22, v22, v130
    v_lshlrev_b32 v23, 16, v22
    v_and_b32 v22, s36, v22
    v_add_f32 v20, v20, v23
    v_add_f32 v20, v20, v22
    v_lshlrev_b32 v22, 16, v131
    v_and_b32 v131, s36, v131
    v_lshlrev_b32 v23, 16, v75
    v_and_b32 v75, s36, v75
    v_mul_f32 v22, v22, v23
    v_mul_f32 v131, v131, v75
    v_cvt_pk_bf16_f32 v22, v22, v131
    v_lshlrev_b32 v23, 16, v22
    v_and_b32 v22, s36, v22
    v_add_f32 v20, v20, v23
    v_add_f32 v20, v20, v22
    v_lshlrev_b32 v22, 16, v132
    v_and_b32 v132, s36, v132
    v_lshlrev_b32 v23, 16, v76
    v_and_b32 v76, s36, v76
    v_mul_f32 v22, v22, v23
    v_mul_f32 v132, v132, v76
    v_cvt_pk_bf16_f32 v22, v22, v132
    v_lshlrev_b32 v23, 16, v22
    v_and_b32 v22, s36, v22
    v_add_f32 v20, v20, v23
    v_add_f32 v20, v20, v22
    v_lshlrev_b32 v22, 16, v133
    v_and_b32 v133, s36, v133
    v_lshlrev_b32 v23, 16, v77
    v_and_b32 v77, s36, v77
    v_mul_f32 v22, v22, v23
    v_mul_f32 v133, v133, v77
    v_cvt_pk_bf16_f32 v22, v22, v133
    v_lshlrev_b32 v23, 16, v22
    v_and_b32 v22, s36, v22
    v_add_f32 v20, v20, v23
    v_add_f32 v20, v20, v22
    v_lshlrev_b32 v22, 16, v134
    v_and_b32 v134, s36, v134
    v_lshlrev_b32 v23, 16, v78
    v_and_b32 v78, s36, v78
    v_mul_f32 v22, v22, v23
    v_mul_f32 v134, v134, v78
    v_cvt_pk_bf16_f32 v22, v22, v134
    v_lshlrev_b32 v23, 16, v22
    v_and_b32 v22, s36, v22
    v_add_f32 v20, v20, v23
    v_add_f32 v20, v20, v22
    v_lshlrev_b32 v22, 16, v135
    v_and_b32 v135, s36, v135
    v_lshlrev_b32 v23, 16, v79
    v_and_b32 v79, s36, v79
    v_mul_f32 v22, v22, v23
    v_mul_f32 v135, v135, v79
    v_cvt_pk_bf16_f32 v22, v22, v135
    v_lshlrev_b32 v23, 16, v22
    v_and_b32 v22, s36, v22
    v_add_f32 v20, v20, v23
    v_add_f32 v20, v20, v22
    v_lshlrev_b32 v22, 16, v136
    v_and_b32 v136, s36, v136
    v_lshlrev_b32 v23, 16, v80
    v_and_b32 v80, s36, v80
    v_mul_f32 v22, v22, v23
    v_mul_f32 v136, v136, v80
    v_cvt_pk_bf16_f32 v22, v22, v136
    v_lshlrev_b32 v23, 16, v22
    v_and_b32 v22, s36, v22
    v_add_f32 v20, v20, v23
    v_add_f32 v20, v20, v22
    v_lshlrev_b32 v22, 16, v137
    v_and_b32 v137, s36, v137
    v_lshlrev_b32 v23, 16, v81
    v_and_b32 v81, s36, v81
    v_mul_f32 v22, v22, v23
    v_mul_f32 v137, v137, v81
    v_cvt_pk_bf16_f32 v22, v22, v137
    v_lshlrev_b32 v23, 16, v22
    v_and_b32 v22, s36, v22
    v_add_f32 v20, v20, v23
    v_add_f32 v20, v20, v22
    v_lshlrev_b32 v22, 16, v138
    v_and_b32 v138, s36, v138
    v_lshlrev_b32 v23, 16, v82
    v_and_b32 v82, s36, v82
    v_mul_f32 v22, v22, v23
    v_mul_f32 v138, v138, v82
    v_cvt_pk_bf16_f32 v22, v22, v138
    v_lshlrev_b32 v23, 16, v22
    v_and_b32 v22, s36, v22
    v_add_f32 v20, v20, v23
    v_add_f32 v20, v20, v22
    v_lshlrev_b32 v22, 16, v139
    v_and_b32 v139, s36, v139
    v_lshlrev_b32 v23, 16, v83
    v_and_b32 v83, s36, v83
    v_mul_f32 v22, v22, v23
    v_mul_f32 v139, v139, v83
    v_cvt_pk_bf16_f32 v22, v22, v139
    v_lshlrev_b32 v23, 16, v22
    v_and_b32 v22, s36, v22
    v_add_f32 v20, v20, v23
    v_add_f32 v20, v20, v22
    v_lshlrev_b32 v22, 16, v140
    v_and_b32 v140, s36, v140
    v_lshlrev_b32 v23, 16, v84
    v_and_b32 v84, s36, v84
    v_mul_f32 v22, v22, v23
    v_mul_f32 v140, v140, v84
    v_cvt_pk_bf16_f32 v22, v22, v140
    v_lshlrev_b32 v23, 16, v22
    v_and_b32 v22, s36, v22
    v_add_f32 v20, v20, v23
    v_add_f32 v20, v20, v22
    v_lshlrev_b32 v22, 16, v141
    v_and_b32 v141, s36, v141
    v_lshlrev_b32 v23, 16, v85
    v_and_b32 v85, s36, v85
    v_mul_f32 v22, v22, v23
    v_mul_f32 v141, v141, v85
    v_cvt_pk_bf16_f32 v22, v22, v141
    v_lshlrev_b32 v23, 16, v22
    v_and_b32 v22, s36, v22
    v_add_f32 v20, v20, v23
    v_add_f32 v20, v20, v22
    v_lshlrev_b32 v22, 16, v142
    v_and_b32 v142, s36, v142
    v_lshlrev_b32 v23, 16, v86
    v_and_b32 v86, s36, v86
    v_mul_f32 v22, v22, v23
    v_mul_f32 v142, v142, v86
    v_cvt_pk_bf16_f32 v22, v22, v142
    v_lshlrev_b32 v23, 16, v22
    v_and_b32 v22, s36, v22
    v_add_f32 v20, v20, v23
    v_add_f32 v20, v20, v22
    v_lshlrev_b32 v22, 16, v143
    v_and_b32 v143, s36, v143
    v_lshlrev_b32 v23, 16, v87
    v_and_b32 v87, s36, v87
    v_mul_f32 v22, v22, v23
    v_mul_f32 v143, v143, v87
    v_cvt_pk_bf16_f32 v22, v22, v143
    v_lshlrev_b32 v23, 16, v22
    v_and_b32 v22, s36, v22
    v_add_f32 v20, v20, v23
    v_add_f32 v20, v20, v22
    v_lshlrev_b32 v22, 16, v144
    v_and_b32 v144, s36, v144
    v_lshlrev_b32 v23, 16, v88
    v_and_b32 v88, s36, v88
    v_mul_f32 v22, v22, v23
    v_mul_f32 v144, v144, v88
    v_cvt_pk_bf16_f32 v22, v22, v144
    v_lshlrev_b32 v23, 16, v22
    v_and_b32 v22, s36, v22
    v_add_f32 v20, v20, v23
    v_add_f32 v20, v20, v22
    v_lshlrev_b32 v22, 16, v145
    v_and_b32 v145, s36, v145
    v_lshlrev_b32 v23, 16, v89
    v_and_b32 v89, s36, v89
    v_mul_f32 v22, v22, v23
    v_mul_f32 v145, v145, v89
    v_cvt_pk_bf16_f32 v22, v22, v145
    v_lshlrev_b32 v23, 16, v22
    v_and_b32 v22, s36, v22
    v_add_f32 v20, v20, v23
    v_add_f32 v20, v20, v22
    v_lshlrev_b32 v22, 16, v146
    v_and_b32 v146, s36, v146
    v_lshlrev_b32 v23, 16, v90
    v_and_b32 v90, s36, v90
    v_mul_f32 v22, v22, v23
    v_mul_f32 v146, v146, v90
    v_cvt_pk_bf16_f32 v22, v22, v146
    v_lshlrev_b32 v23, 16, v22
    v_and_b32 v22, s36, v22
    v_add_f32 v20, v20, v23
    v_add_f32 v20, v20, v22
    v_lshlrev_b32 v22, 16, v147
    v_and_b32 v147, s36, v147
    v_lshlrev_b32 v23, 16, v91
    v_and_b32 v91, s36, v91
    v_mul_f32 v22, v22, v23
    v_mul_f32 v147, v147, v91
    v_cvt_pk_bf16_f32 v22, v22, v147
    v_lshlrev_b32 v23, 16, v22
    v_and_b32 v22, s36, v22
    v_add_f32 v20, v20, v23
    v_add_f32 v20, v20, v22
    v_lshlrev_b32 v22, 16, v148
    v_and_b32 v148, s36, v148
    v_lshlrev_b32 v23, 16, v92
    v_and_b32 v92, s36, v92
    v_mul_f32 v22, v22, v23
    v_mul_f32 v148, v148, v92
    v_cvt_pk_bf16_f32 v22, v22, v148
    v_lshlrev_b32 v23, 16, v22
    v_and_b32 v22, s36, v22
    v_add_f32 v20, v20, v23
    v_add_f32 v20, v20, v22
    v_lshlrev_b32 v22, 16, v149
    v_and_b32 v149, s36, v149
    v_lshlrev_b32 v23, 16, v93
    v_and_b32 v93, s36, v93
    v_mul_f32 v22, v22, v23
    v_mul_f32 v149, v149, v93
    v_cvt_pk_bf16_f32 v22, v22, v149
    v_lshlrev_b32 v23, 16, v22
    v_and_b32 v22, s36, v22
    v_add_f32 v20, v20, v23
    v_add_f32 v20, v20, v22
    v_lshlrev_b32 v22, 16, v150
    v_and_b32 v150, s36, v150
    v_lshlrev_b32 v23, 16, v94
    v_and_b32 v94, s36, v94
    v_mul_f32 v22, v22, v23
    v_mul_f32 v150, v150, v94
    v_cvt_pk_bf16_f32 v22, v22, v150
    v_lshlrev_b32 v23, 16, v22
    v_and_b32 v22, s36, v22
    v_add_f32 v20, v20, v23
    v_add_f32 v20, v20, v22
    v_lshlrev_b32 v22, 16, v151
    v_and_b32 v151, s36, v151
    v_lshlrev_b32 v23, 16, v95
    v_and_b32 v95, s36, v95
    v_mul_f32 v22, v22, v23
    v_mul_f32 v151, v151, v95
    v_cvt_pk_bf16_f32 v22, v22, v151
    v_lshlrev_b32 v23, 16, v22
    v_and_b32 v22, s36, v22
    v_add_f32 v20, v20, v23
    v_add_f32 v20, v20, v22
    v_lshlrev_b32 v22, 16, v152
    v_and_b32 v152, s36, v152
    v_lshlrev_b32 v23, 16, v96
    v_and_b32 v96, s36, v96
    v_mul_f32 v22, v22, v23
    v_mul_f32 v152, v152, v96
    v_cvt_pk_bf16_f32 v22, v22, v152
    v_lshlrev_b32 v23, 16, v22
    v_and_b32 v22, s36, v22
    v_add_f32 v20, v20, v23
    v_add_f32 v20, v20, v22
    v_lshlrev_b32 v22, 16, v153
    v_and_b32 v153, s36, v153
    v_lshlrev_b32 v23, 16, v97
    v_and_b32 v97, s36, v97
    v_mul_f32 v22, v22, v23
    v_mul_f32 v153, v153, v97
    v_cvt_pk_bf16_f32 v22, v22, v153
    v_lshlrev_b32 v23, 16, v22
    v_and_b32 v22, s36, v22
    v_add_f32 v20, v20, v23
    v_add_f32 v20, v20, v22
    v_lshlrev_b32 v22, 16, v154
    v_and_b32 v154, s36, v154
    v_lshlrev_b32 v23, 16, v98
    v_and_b32 v98, s36, v98
    v_mul_f32 v22, v22, v23
    v_mul_f32 v154, v154, v98
    v_cvt_pk_bf16_f32 v22, v22, v154
    v_lshlrev_b32 v23, 16, v22
    v_and_b32 v22, s36, v22
    v_add_f32 v20, v20, v23
    v_add_f32 v20, v20, v22
    v_lshlrev_b32 v22, 16, v155
    v_and_b32 v155, s36, v155
    v_lshlrev_b32 v23, 16, v99
    v_and_b32 v99, s36, v99
    v_mul_f32 v22, v22, v23
    v_mul_f32 v155, v155, v99
    v_cvt_pk_bf16_f32 v22, v22, v155
    v_lshlrev_b32 v23, 16, v22
    v_and_b32 v22, s36, v22
    v_add_f32 v20, v20, v23
    v_add_f32 v20, v20, v22
    v_lshlrev_b32 v22, 16, v156
    v_and_b32 v156, s36, v156
    v_lshlrev_b32 v23, 16, v100
    v_and_b32 v100, s36, v100
    v_mul_f32 v22, v22, v23
    v_mul_f32 v156, v156, v100
    v_cvt_pk_bf16_f32 v22, v22, v156
    v_lshlrev_b32 v23, 16, v22
    v_and_b32 v22, s36, v22
    v_add_f32 v20, v20, v23
    v_add_f32 v20, v20, v22
    v_lshlrev_b32 v22, 16, v157
    v_and_b32 v157, s36, v157
    v_lshlrev_b32 v23, 16, v101
    v_and_b32 v101, s36, v101
    v_mul_f32 v22, v22, v23
    v_mul_f32 v157, v157, v101
    v_cvt_pk_bf16_f32 v22, v22, v157
    v_lshlrev_b32 v23, 16, v22
    v_and_b32 v22, s36, v22
    v_add_f32 v20, v20, v23
    v_add_f32 v20, v20, v22
    v_lshlrev_b32 v22, 16, v158
    v_and_b32 v158, s36, v158
    v_lshlrev_b32 v23, 16, v102
    v_and_b32 v102, s36, v102
    v_mul_f32 v22, v22, v23
    v_mul_f32 v158, v158, v102
    v_cvt_pk_bf16_f32 v22, v22, v158
    v_lshlrev_b32 v23, 16, v22
    v_and_b32 v22, s36, v22
    v_add_f32 v20, v20, v23
    v_add_f32 v20, v20, v22
    v_lshlrev_b32 v22, 16, v159
    v_and_b32 v159, s36, v159
    v_lshlrev_b32 v23, 16, v103
    v_and_b32 v103, s36, v103
    v_mul_f32 v22, v22, v23
    v_mul_f32 v159, v159, v103
    v_cvt_pk_bf16_f32 v22, v22, v159
    v_lshlrev_b32 v23, 16, v22
    v_and_b32 v22, s36, v22
    v_add_f32 v20, v20, v23
    v_add_f32 v20, v20, v22
    v_lshlrev_b32 v22, 16, v160
    v_and_b32 v160, s36, v160
    v_lshlrev_b32 v23, 16, v104
    v_and_b32 v104, s36, v104
    v_mul_f32 v22, v22, v23
    v_mul_f32 v160, v160, v104
    v_cvt_pk_bf16_f32 v22, v22, v160
    v_lshlrev_b32 v23, 16, v22
    v_and_b32 v22, s36, v22
    v_add_f32 v20, v20, v23
    v_add_f32 v20, v20, v22
    v_lshlrev_b32 v22, 16, v161
    v_and_b32 v161, s36, v161
    v_lshlrev_b32 v23, 16, v105
    v_and_b32 v105, s36, v105
    v_mul_f32 v22, v22, v23
    v_mul_f32 v161, v161, v105
    v_cvt_pk_bf16_f32 v22, v22, v161
    v_lshlrev_b32 v23, 16, v22
    v_and_b32 v22, s36, v22
    v_add_f32 v20, v20, v23
    v_add_f32 v20, v20, v22
    v_lshlrev_b32 v22, 16, v162
    v_and_b32 v162, s36, v162
    v_lshlrev_b32 v23, 16, v106
    v_and_b32 v106, s36, v106
    v_mul_f32 v22, v22, v23
    v_mul_f32 v162, v162, v106
    v_cvt_pk_bf16_f32 v22, v22, v162
    v_lshlrev_b32 v23, 16, v22
    v_and_b32 v22, s36, v22
    v_add_f32 v20, v20, v23
    v_add_f32 v20, v20, v22
    v_lshlrev_b32 v22, 16, v163
    v_and_b32 v163, s36, v163
    v_lshlrev_b32 v23, 16, v107
    v_and_b32 v107, s36, v107
    v_mul_f32 v22, v22, v23
    v_mul_f32 v163, v163, v107
    v_cvt_pk_bf16_f32 v22, v22, v163
    v_lshlrev_b32 v23, 16, v22
    v_and_b32 v22, s36, v22
    v_add_f32 v20, v20, v23
    v_add_f32 v20, v20, v22
    v_lshlrev_b32 v22, 16, v164
    v_and_b32 v164, s36, v164
    v_lshlrev_b32 v23, 16, v108
    v_and_b32 v108, s36, v108
    v_mul_f32 v22, v22, v23
    v_mul_f32 v164, v164, v108
    v_cvt_pk_bf16_f32 v22, v22, v164
    v_lshlrev_b32 v23, 16, v22
    v_and_b32 v22, s36, v22
    v_add_f32 v20, v20, v23
    v_add_f32 v20, v20, v22
    v_lshlrev_b32 v22, 16, v165
    v_and_b32 v165, s36, v165
    v_lshlrev_b32 v23, 16, v109
    v_and_b32 v109, s36, v109
    v_mul_f32 v22, v22, v23
    v_mul_f32 v165, v165, v109
    v_cvt_pk_bf16_f32 v22, v22, v165
    v_lshlrev_b32 v23, 16, v22
    v_and_b32 v22, s36, v22
    v_add_f32 v20, v20, v23
    v_add_f32 v20, v20, v22
    v_lshlrev_b32 v22, 16, v166
    v_and_b32 v166, s36, v166
    v_lshlrev_b32 v23, 16, v110
    v_and_b32 v110, s36, v110
    v_mul_f32 v22, v22, v23
    v_mul_f32 v166, v166, v110
    v_cvt_pk_bf16_f32 v22, v22, v166
    v_lshlrev_b32 v23, 16, v22
    v_and_b32 v22, s36, v22
    v_add_f32 v20, v20, v23
    v_add_f32 v20, v20, v22
    v_lshlrev_b32 v22, 16, v167
    v_and_b32 v167, s36, v167
    v_lshlrev_b32 v23, 16, v111
    v_and_b32 v111, s36, v111
    v_mul_f32 v22, v22, v23
    v_mul_f32 v167, v167, v111
    v_cvt_pk_bf16_f32 v22, v22, v167
    v_lshlrev_b32 v23, 16, v22
    v_and_b32 v22, s36, v22
    v_add_f32 v20, v20, v23
    v_add_f32 v20, v20, v22
    v_lshlrev_b32 v22, 16, v168
    v_and_b32 v168, s36, v168
    v_lshlrev_b32 v23, 16, v112
    v_and_b32 v112, s36, v112
    v_mul_f32 v22, v22, v23
    v_mul_f32 v168, v168, v112
    v_cvt_pk_bf16_f32 v22, v22, v168
    v_lshlrev_b32 v23, 16, v22
    v_and_b32 v22, s36, v22
    v_add_f32 v20, v20, v23
    v_add_f32 v20, v20, v22
    v_lshlrev_b32 v22, 16, v169
    v_and_b32 v169, s36, v169
    v_lshlrev_b32 v23, 16, v113
    v_and_b32 v113, s36, v113
    v_mul_f32 v22, v22, v23
    v_mul_f32 v169, v169, v113
    v_cvt_pk_bf16_f32 v22, v22, v169
    v_lshlrev_b32 v23, 16, v22
    v_and_b32 v22, s36, v22
    v_add_f32 v20, v20, v23
    v_add_f32 v20, v20, v22
    v_lshlrev_b32 v22, 16, v170
    v_and_b32 v170, s36, v170
    v_lshlrev_b32 v23, 16, v114
    v_and_b32 v114, s36, v114
    v_mul_f32 v22, v22, v23
    v_mul_f32 v170, v170, v114
    v_cvt_pk_bf16_f32 v22, v22, v170
    v_lshlrev_b32 v23, 16, v22
    v_and_b32 v22, s36, v22
    v_add_f32 v20, v20, v23
    v_add_f32 v20, v20, v22
    v_lshlrev_b32 v22, 16, v171
    v_and_b32 v171, s36, v171
    v_lshlrev_b32 v23, 16, v115
    v_and_b32 v115, s36, v115
    v_mul_f32 v22, v22, v23
    v_mul_f32 v171, v171, v115
    v_cvt_pk_bf16_f32 v22, v22, v171
    v_lshlrev_b32 v23, 16, v22
    v_and_b32 v22, s36, v22
    v_add_f32 v20, v20, v23
    v_add_f32 v20, v20, v22
    v_lshlrev_b32 v22, 16, v172
    v_and_b32 v172, s36, v172
    v_lshlrev_b32 v23, 16, v116
    v_and_b32 v116, s36, v116
    v_mul_f32 v22, v22, v23
    v_mul_f32 v172, v172, v116
    v_cvt_pk_bf16_f32 v22, v22, v172
    v_lshlrev_b32 v23, 16, v22
    v_and_b32 v22, s36, v22
    v_add_f32 v20, v20, v23
    v_add_f32 v20, v20, v22
    v_lshlrev_b32 v22, 16, v173
    v_and_b32 v173, s36, v173
    v_lshlrev_b32 v23, 16, v117
    v_and_b32 v117, s36, v117
    v_mul_f32 v22, v22, v23
    v_mul_f32 v173, v173, v117
    v_cvt_pk_bf16_f32 v22, v22, v173
    v_lshlrev_b32 v23, 16, v22
    v_and_b32 v22, s36, v22
    v_add_f32 v20, v20, v23
    v_add_f32 v20, v20, v22
    v_lshlrev_b32 v22, 16, v174
    v_and_b32 v174, s36, v174
    v_lshlrev_b32 v23, 16, v118
    v_and_b32 v118, s36, v118
    v_mul_f32 v22, v22, v23
    v_mul_f32 v174, v174, v118
    v_cvt_pk_bf16_f32 v22, v22, v174
    v_lshlrev_b32 v23, 16, v22
    v_and_b32 v22, s36, v22
    v_add_f32 v20, v20, v23
    v_add_f32 v20, v20, v22
    v_lshlrev_b32 v22, 16, v175
    v_and_b32 v175, s36, v175
    v_lshlrev_b32 v23, 16, v119
    v_and_b32 v119, s36, v119
    v_mul_f32 v22, v22, v23
    v_mul_f32 v175, v175, v119
    v_cvt_pk_bf16_f32 v22, v22, v175
    v_lshlrev_b32 v23, 16, v22
    v_and_b32 v22, s36, v22
    v_add_f32 v20, v20, v23
    v_add_f32 v20, v20, v22
    s_nop 1
    v_add_f32_dpp v20, v20, v20 quad_perm:[1,0,3,2] row_mask:0xf bank_mask:0xf
    s_nop 1
    v_add_f32_dpp v20, v20, v20 quad_perm:[2,3,0,1] row_mask:0xf bank_mask:0xf
    v_cvt_pk_bf16_f32 v20, v20, v20
    v_lshlrev_b32 v20, 16, v20
    v_mul_f32 v20, 0xbfb8aa3b, v20
    v_exp_f32 v20, v20
    s_nop 0
    v_add_f32 v20, 1.0, v20
    v_rcp_f32 v20, v20
    s_nop 0
    v_cvt_pk_bf16_f32 v20, v20, v20
    v_lshlrev_b32 v20, 16, v20
    v_lshrrev_b32 v10, 2, v0
    v_lshlrev_b32 v10, 2, v10
    s_lshl_b32 s24, s4, 4
    s_add_u32 s24, s24, s5
    s_lshl_b32 s24, s24, 2
    v_and_b32 v11, 3, v0
    v_cmp_eq_u32 vcc, 0, v11
    s_and_saveexec_b64 s[38:39], vcc
    buffer_store_dword v20, v10, s[20:23], s24 offen sc1
    s_mov_b64 exec, s[38:39]
    s_waitcnt vmcnt(0)
    s_barrier
    s_cmp_lg_u32 s4, 0
    s_cbranch_scc1 aux_done
    s_mul_i32 s24, s48, 896
    s_add_u32 s24, s24, 56
    v_mul_u32_u24 v10, 128, v0
    v_mov_b32 v11, s37
    s_mov_b64 exec, 0x7f
    buffer_store_dword v11, v10, s[52:55], s24 offen sc1
    s_mov_b64 exec, -1
aux_done:
    s_load_dwordx2 s[92:93], s[0:1], 96
    v_lshrrev_b32 v10, 4, v0
    v_lshrrev_b32 v11, 3, v0
    v_and_b32 v12, 7, v0
    v_and_b32 v13, 1, v10
    v_lshlrev_b32 v13, 2, v13
    v_xor_b32 v13, v13, v12
    v_lshlrev_b32 v13, 4, v13
    v_mul_u32_u24 v12, 896, v11
    v_add_u32 v20, v12, v13
    v_add_u32 v19, 6144, v20
    s_lshr_b32 s99, s3, 3
    s_and_b32 s100, s99, 3
    s_mul_i32 s100, s100, 3
    s_lshr_b32 s99, s99, 2
    s_lshl_b32 s101, s99, 1
    s_add_u32 s100, s100, s101
    s_sub_u32 s101, s100, 14
    s_cmp_ge_u32 s100, 14
    s_cselect_b32 s100, s101, s100
    s_mov_b32 s38, s100
    s_and_b32 s101, s3, 1
    s_mul_i32 s39, s101, 14
    s_lshl_b32 s101, s4, 4
    s_mul_i32 s47, s101, 896
    s_lshl_b32 s99, s99, 7
    s_add_u32 s47, s47, s99
    s_add_u32 s99, s39, 14
    s_mul_i32 s99, s99, 57344
    s_add_u32 s97, s47, s99
    s_add_u32 s99, s39, s100
    s_mul_i32 s99, s99, 57344
    s_add_u32 s96, s47, s99
    s_lshl_b32 s98, s4, 11
    s_waitcnt lgkmcnt(0)
    s_mov_b32 s94, 1605632
    s_mov_b32 s95, 0x20000
    s_load_dwordx2 s[100:101], s[0:1], 128
    s_and_b32 s99, s3, 7
    s_lshl_b32 s99, s99, 2
    s_lshr_b32 s45, s3, 3
    s_and_b32 s44, s45, 3
    s_add_u32 s99, s99, s44
    s_lshr_b32 s45, s45, 2
    s_mul_i32 s41, s99, 7
    s_add_u32 s41, s41, s45
    s_lshl_b32 s41, s41, 7
    s_lshl_b32 s44, s99, 6
    s_lshl_b32 s45, s45, 6
    s_lshl_b32 s99, s4, 4
    s_add_u32 s40, s44, s99
    s_mul_i32 s40, s40, 3584
    s_add_u32 s99, s39, 14
    s_lshl_b32 s99, s99, 7
    s_add_u32 s43, s40, s99
    s_add_u32 s99, s39, s38
    s_lshl_b32 s99, s99, 7
    s_add_u32 s42, s40, s99
    s_lshr_b32 s46, s39, 1
    s_lshl_b32 s46, 0x7f, s46
    v_lshrrev_b32 v10, 4, v0
    v_lshrrev_b32 v11, 3, v0
    v_and_b32 v12, 7, v0
    v_xor_b32 v13, v12, v10
    v_lshlrev_b32 v13, 4, v13
    v_mul_u32_u24 v9, 3584, v11
    v_add_u32 v86, v9, v13
    v_xor_b32 v13, 64, v13
    v_add_u32 v87, v9, v13
    v_add_u32 v87, 27648, v87
    v_and_b32 v10, 31, v0
    v_lshrrev_b32 v11, 5, v0
    v_lshrrev_b32 v12, 1, v10
    v_and_b32 v12, 7, v12
    s_lshl_b32 s99, s4, 1
    v_add_u32 v11, s99, v11
    v_xor_b32 v12, v12, v11
    v_lshlrev_b32 v12, 4, v12
    v_lshlrev_b32 v10, 7, v10
    v_add_u32 v88, v10, v12
    v_lshrrev_b32 v10, 4, v0
    v_lshrrev_b32 v11, 2, v0
    v_and_b32 v11, 3, v11
    v_and_b32 v12, 3, v0
    v_lshrrev_b32 v13, 1, v10
    v_lshlrev_b32 v13, 3, v13
    v_add_u32 v13, v13, v11
    s_lshl_b32 s99, s4, 4
    v_add_u32 v13, s99, v13
    v_lshlrev_b32 v13, 7, v13
    v_lshrrev_b32 v9, 1, v12
    v_lshlrev_b32 v9, 3, v9
    v_add_u32 v13, v13, v9
    v_and_b32 v9, 1, v10
    v_lshlrev_b32 v9, 1, v9
    v_and_b32 v18, 1, v12
    v_add_u32 v9, v9, v18
    v_lshrrev_b32 v18, 1, v11
    v_lshlrev_b32 v18, 2, v18
    v_xor_b32 v9, v9, v18
    v_lshlrev_b32 v18, 4, v9
    v_add_u32 v89, v13, v18
    v_xor_b32 v18, 64, v18
    v_add_u32 v90, v13, v18
    s_waitcnt lgkmcnt(0)
    s_add_u32 s48, s100, 14876672
    s_addc_u32 s49, s101, 0
    s_mov_b32 s50, 114688
    s_mov_b32 s51, 0x20000
    s_load_dwordx2 s[28:29], s[0:1], 128
    s_waitcnt lgkmcnt(0)
    s_mov_b32 s16, s28
    s_mov_b32 s17, s29
    s_mov_b32 s18, 7340032
    s_mov_b32 s19, 0x20000
    s_barrier
    s_add_u32 m0, s98, 32768
    s_nop 0
    buffer_load_dwordx4 v20, s[92:95], s96 offen lds
    buffer_load_dwordx4 v19, s[92:95], s96 offen offset:1024 lds
    s_add_u32 s96, s96, 57344
    s_sub_u32 s99, s96, 802816
    s_cmp_ge_u32 s96, s97
    s_cselect_b32 s96, s99, s96
    s_add_u32 m0, s98, 40960
    s_nop 0
    buffer_load_dwordx4 v20, s[92:95], s96 offen lds
    buffer_load_dwordx4 v19, s[92:95], s96 offen offset:1024 lds
    s_add_u32 s96, s96, 57344
    s_sub_u32 s99, s96, 802816
    s_cmp_ge_u32 s96, s97
    s_cselect_b32 s96, s99, s96
    s_add_u32 m0, s98, 65536
    s_nop 0
    buffer_load_dwordx4 v20, s[92:95], s96 offen lds
    buffer_load_dwordx4 v19, s[92:95], s96 offen offset:1024 lds
    s_add_u32 s96, s96, 57344
    s_sub_u32 s99, s96, 802816
    s_cmp_ge_u32 s96, s97
    s_cselect_b32 s96, s99, s96
    s_add_u32 m0, s98, 73728
    s_nop 0
    buffer_load_dwordx4 v20, s[92:95], s96 offen lds
    buffer_load_dwordx4 v19, s[92:95], s96 offen offset:1024 lds
    s_add_u32 s96, s96, 57344
    s_sub_u32 s99, s96, 802816
    s_cmp_ge_u32 s96, s97
    s_cselect_b32 s96, s99, s96
    s_add_u32 m0, s98, 49152
    s_nop 0
    buffer_load_dwordx4 v20, s[92:95], s96 offen lds
    buffer_load_dwordx4 v19, s[92:95], s96 offen offset:1024 lds
    s_add_u32 s96, s96, 57344
    s_sub_u32 s99, s96, 802816
    s_cmp_ge_u32 s96, s97
    s_cselect_b32 s96, s99, s96
    s_add_u32 m0, s98, 57344
    s_nop 0
    buffer_load_dwordx4 v20, s[92:95], s96 offen lds
    buffer_load_dwordx4 v19, s[92:95], s96 offen offset:1024 lds
    s_add_u32 s96, s96, 57344
    s_sub_u32 s99, s96, 802816
    s_cmp_ge_u32 s96, s97
    s_cselect_b32 s96, s99, s96
    s_waitcnt vmcnt(0)
    s_add_u32 m0, s98, 0
    s_nop 0
    buffer_load_dwordx4 v20, s[92:95], s96 offen lds
    buffer_load_dwordx4 v19, s[92:95], s96 offen offset:1024 lds
    s_add_u32 s96, s96, 57344
    s_sub_u32 s99, s96, 802816
    s_cmp_ge_u32 s96, s97
    s_cselect_b32 s96, s99, s96
    s_add_u32 m0, s98, 8192
    s_nop 0
    buffer_load_dwordx4 v20, s[92:95], s96 offen lds
    buffer_load_dwordx4 v19, s[92:95], s96 offen offset:1024 lds
    s_add_u32 s96, s96, 57344
    s_sub_u32 s99, s96, 802816
    s_cmp_ge_u32 s96, s97
    s_cselect_b32 s96, s99, s96
    s_add_u32 m0, s98, 16384
    s_nop 0
    buffer_load_dwordx4 v20, s[92:95], s96 offen lds
    buffer_load_dwordx4 v19, s[92:95], s96 offen offset:1024 lds
    s_add_u32 s96, s96, 57344
    s_sub_u32 s99, s96, 802816
    s_cmp_ge_u32 s96, s97
    s_cselect_b32 s96, s99, s96
    s_add_u32 m0, s98, 24576
    s_nop 0
    buffer_load_dwordx4 v20, s[92:95], s96 offen lds
    buffer_load_dwordx4 v19, s[92:95], s96 offen offset:1024 lds
    s_add_u32 s96, s96, 57344
    s_sub_u32 s99, s96, 802816
    s_cmp_ge_u32 s96, s97
    s_cselect_b32 s96, s99, s96
    s_mov_b32 s58, 0
f_g2:
    s_lshr_b32 s99, s3, 3
    s_cmp_ge_u32 s99, 28
    s_cbranch_scc1 f_early
    s_load_dwordx2 s[28:29], s[0:1], 128
    s_load_dwordx2 s[30:31], s[0:1], 112
    s_setprio 3
    v_mov_b32 v2, v86
    v_mov_b32 v3, v87
    v_mov_b32 v5, v88
    v_mov_b32 v6, v89
    v_mov_b32 v7, v90
    v_add_u32 v16, 0x10000, v5
    v_add_u32 v17, 0x10000, v6
    v_add_u32 v18, 0x10000, v7
    s_waitcnt vmcnt(16)
    ds_read_b64_tr_b16 v[128:129], v6 offset:32768
    ds_read_b64_tr_b16 v[130:131], v6 offset:33280
    ds_read_b64_tr_b16 v[132:133], v7 offset:32768
    ds_read_b64_tr_b16 v[134:135], v7 offset:33280
    ds_read_b64_tr_b16 v[136:137], v6 offset:40960
    ds_read_b64_tr_b16 v[138:139], v6 offset:41472
    ds_read_b64_tr_b16 v[140:141], v7 offset:40960
    ds_read_b64_tr_b16 v[142:143], v7 offset:41472
    ds_read_b64_tr_b16 v[144:145], v17 offset:0
    ds_read_b64_tr_b16 v[146:147], v17 offset:512
    ds_read_b64_tr_b16 v[148:149], v18 offset:0
    ds_read_b64_tr_b16 v[150:151], v18 offset:512
    ds_read_b64_tr_b16 v[152:153], v17 offset:8192
    ds_read_b64_tr_b16 v[154:155], v17 offset:8704
    ds_read_b64_tr_b16 v[156:157], v18 offset:8192
    ds_read_b64_tr_b16 v[158:159], v18 offset:8704
    ds_read_b64_tr_b16 v[160:161], v6 offset:49152
    ds_read_b64_tr_b16 v[162:163], v6 offset:49664
    ds_read_b64_tr_b16 v[164:165], v7 offset:49152
    ds_read_b64_tr_b16 v[166:167], v7 offset:49664
    ds_read_b64_tr_b16 v[168:169], v6 offset:57344
    ds_read_b64_tr_b16 v[170:171], v6 offset:57856
    ds_read_b64_tr_b16 v[172:173], v7 offset:57344
    ds_read_b64_tr_b16 v[174:175], v7 offset:57856
    s_waitcnt lgkmcnt(0)
    s_add_u32 m0, s98, 32768
    s_nop 0
    buffer_load_dwordx4 v20, s[92:95], s96 offen lds
    buffer_load_dwordx4 v19, s[92:95], s96 offen offset:1024 lds
    s_add_u32 s96, s96, 57344
    s_sub_u32 s99, s96, 802816
    s_cmp_ge_u32 s96, s97
    s_cselect_b32 s96, s99, s96
    s_add_u32 m0, s98, 40960
    s_nop 0
    buffer_load_dwordx4 v20, s[92:95], s96 offen lds
    buffer_load_dwordx4 v19, s[92:95], s96 offen offset:1024 lds
    s_add_u32 s96, s96, 57344
    s_sub_u32 s99, s96, 802816
    s_cmp_ge_u32 s96, s97
    s_cselect_b32 s96, s99, s96
    s_add_u32 m0, s98, 65536
    s_nop 0
    buffer_load_dwordx4 v20, s[92:95], s96 offen lds
    buffer_load_dwordx4 v19, s[92:95], s96 offen offset:1024 lds
    s_add_u32 s96, s96, 57344
    s_sub_u32 s99, s96, 802816
    s_cmp_ge_u32 s96, s97
    s_cselect_b32 s96, s99, s96
    s_add_u32 m0, s98, 73728
    s_nop 0
    buffer_load_dwordx4 v20, s[92:95], s96 offen lds
    buffer_load_dwordx4 v19, s[92:95], s96 offen offset:1024 lds
    s_sub_u32 s99, 28, s39
    s_mul_i32 s99, s99, 57344
    s_add_u32 s97, s47, s99
    s_sub_u32 s99, 14, s39
    s_add_u32 s99, s99, s38
    s_mul_i32 s99, s99, 57344
    s_add_u32 s96, s47, s99
    s_add_u32 m0, s98, 49152
    s_nop 0
    buffer_load_dwordx4 v20, s[92:95], s96 offen lds
    buffer_load_dwordx4 v19, s[92:95], s96 offen offset:1024 lds
    s_add_u32 s96, s96, 57344
    s_sub_u32 s99, s96, 802816
    s_cmp_ge_u32 s96, s97
    s_cselect_b32 s96, s99, s96
    s_add_u32 m0, s98, 57344
    s_nop 0
    buffer_load_dwordx4 v20, s[92:95], s96 offen lds
    buffer_load_dwordx4 v19, s[92:95], s96 offen offset:1024 lds
    s_add_u32 s96, s96, 57344
    s_sub_u32 s99, s96, 802816
    s_cmp_ge_u32 s96, s97
    s_cselect_b32 s96, s99, s96
    s_waitcnt vmcnt(20)
    s_barrier
    s_cmp_lg_u32 s4, 0
    s_cbranch_scc1 g2_flagged
    s_cmp_eq_u32 s58, 0
    s_cbranch_scc1 g2_flagged
    v_mul_u32_u24 v10, 128, v0
    v_mov_b32 v11, s37
    s_mov_b64 exec, 0x3fff
    buffer_store_dword v11, v10, s[48:51], s57 offen sc1
    s_mov_b64 exec, -1
g2_flagged:
    s_waitcnt vmcnt(18)
    ds_read_b64_tr_b16 v[176:177], v6 offset:0
    ds_read_b64_tr_b16 v[178:179], v6 offset:512
    ds_read_b64_tr_b16 v[180:181], v7 offset:0
    ds_read_b64_tr_b16 v[182:183], v7 offset:512
    s_waitcnt vmcnt(16)
    ds_read_b64_tr_b16 v[184:185], v6 offset:8192
    ds_read_b64_tr_b16 v[186:187], v6 offset:8704
    ds_read_b64_tr_b16 v[188:189], v7 offset:8192
    ds_read_b64_tr_b16 v[190:191], v7 offset:8704
    s_waitcnt vmcnt(14)
    ds_read_b64_tr_b16 v[192:193], v6 offset:16384
    ds_read_b64_tr_b16 v[194:195], v6 offset:16896
    ds_read_b64_tr_b16 v[196:197], v7 offset:16384
    ds_read_b64_tr_b16 v[198:199], v7 offset:16896
    s_waitcnt vmcnt(12)
    ds_read_b64_tr_b16 v[200:201], v6 offset:24576
    ds_read_b64_tr_b16 v[202:203], v6 offset:25088
    ds_read_b64_tr_b16 v[204:205], v7 offset:24576
    ds_read_b64_tr_b16 v[206:207], v7 offset:25088
    s_waitcnt vmcnt(10)
    ds_read_b64_tr_b16 v[208:209], v6 offset:32768
    ds_read_b64_tr_b16 v[210:211], v6 offset:33280
    ds_read_b64_tr_b16 v[212:213], v7 offset:32768
    ds_read_b64_tr_b16 v[214:215], v7 offset:33280
    s_waitcnt vmcnt(8)
    ds_read_b64_tr_b16 v[216:217], v6 offset:40960
    ds_read_b64_tr_b16 v[218:219], v6 offset:41472
    ds_read_b64_tr_b16 v[220:221], v7 offset:40960
    ds_read_b64_tr_b16 v[222:223], v7 offset:41472
    s_waitcnt vmcnt(6)
    ds_read_b64_tr_b16 v[224:225], v17 offset:0
    ds_read_b64_tr_b16 v[226:227], v17 offset:512
    ds_read_b64_tr_b16 v[228:229], v18 offset:0
    ds_read_b64_tr_b16 v[230:231], v18 offset:512
    s_waitcnt vmcnt(4)
    ds_read_b64_tr_b16 v[232:233], v17 offset:8192
    ds_read_b64_tr_b16 v[234:235], v17 offset:8704
    ds_read_b64_tr_b16 v[236:237], v18 offset:8192
    ds_read_b64_tr_b16 v[238:239], v18 offset:8704
    s_waitcnt vmcnt(2)
    ds_read_b64_tr_b16 v[240:241], v6 offset:49152
    ds_read_b64_tr_b16 v[242:243], v6 offset:49664
    ds_read_b64_tr_b16 v[244:245], v7 offset:49152
    ds_read_b64_tr_b16 v[246:247], v7 offset:49664
    s_waitcnt vmcnt(0)
    ds_read_b64_tr_b16 v[248:249], v6 offset:57344
    ds_read_b64_tr_b16 v[250:251], v6 offset:57856
    ds_read_b64_tr_b16 v[252:253], v7 offset:57344
    ds_read_b64_tr_b16 v[254:255], v7 offset:57856
    s_waitcnt lgkmcnt(0)
    v_lshlrev_b32 v11, 4, v0
    s_lshl_b32 s24, s4, 12
    v_add_u32 v56, s24, v11
    s_lshl_b32 s24, s4, 14
    v_add_u32 v12, s24, v11
    s_add_u32 s24, s4, 1
    s_and_b32 s24, s24, 3
    s_lshl_b32 s24, s24, 12
    v_add_u32 v57, s24, v12
    s_add_u32 s24, s4, 2
    s_and_b32 s24, s24, 3
    s_lshl_b32 s24, s24, 12
    v_add_u32 v58, s24, v12
    s_add_u32 s24, s4, 3
    s_and_b32 s24, s24, 3
    s_lshl_b32 s24, s24, 12
    v_add_u32 v59, s24, v12
    v_lshrrev_b32 v10, 4, v0
    v_lshrrev_b32 v13, 2, v0
    v_and_b32 v13, 3, v13
    v_and_b32 v14, 3, v0
    v_lshrrev_b32 v15, 1, v10
    v_lshlrev_b32 v15, 3, v15
    v_add_u32 v15, v15, v13
    v_lshlrev_b32 v15, 7, v15
    v_and_b32 v9, 1, v10
    v_lshlrev_b32 v9, 5, v9
    v_add_u32 v15, v15, v9
    v_lshlrev_b32 v14, 3, v14
    v_add_u32 v15, v15, v14
    s_lshr_b32 s24, s4, 1
    s_lshl_b32 s24, s24, 12
    s_and_b32 s25, s4, 1
    s_lshl_b32 s25, s25, 6
    s_add_u32 s24, s24, s25
    s_add_u32 s24, s24, 65536
    v_add_u32 v60, s24, v15
    v_and_b32 v10, 31, v0
    v_lshrrev_b32 v11, 5, v0
    s_and_b32 s24, s4, 1
    s_lshl_b32 s24, s24, 5
    v_add_u32 v10, s24, v10
    s_lshr_b32 s25, s4, 1
    s_lshl_b32 s25, s25, 2
    v_add_u32 v11, s25, v11
    v_and_b32 v12, 7, v10
    v_xor_b32 v11, v11, v12
    v_lshlrev_b32 v10, 7, v10
    v_lshlrev_b32 v12, 4, v11
    v_add_u32 v61, v10, v12
    v_xor_b32 v12, 32, v12
    v_add_u32 v62, v10, v12
    v_lshrrev_b32 v10, 3, v0
    v_and_b32 v11, 7, v0
    v_xor_b32 v11, v11, v10
    v_lshlrev_b32 v11, 4, v11
    v_mul_u32_u24 v10, 896, v10
    v_add_u32 v23, v10, v11
    v_lshlrev_b32 v12, 4, v0
    v_add_u32 v63, s98, v12
    s_lshl_b32 s24, s4, 4
    s_add_u32 s24, s24, s44
    s_mul_i32 s24, s24, 896
    s_lshl_b32 s32, s45, 1
    s_add_u32 s32, s32, s24
    s_mov_b32 s101, 114688
    s_mov_b32 s100, 114688
    s_cmp_lg_u32 s4, 0
    s_cbranch_scc1 g2_hready
    v_and_b32 v10, 31, v0
    v_lshlrev_b32 v10, 2, v10
    s_mov_b32 s34, 0
g2_wh:
    buffer_load_dword v11, v10, s[48:51], s41 offen sc1
    s_waitcnt vmcnt(0)
    v_cmp_eq_u32 vcc, s37, v11
    s_add_u32 s34, s34, 1
    s_cmp_ge_u32 s34, 400000
    s_cbranch_scc1 g2_wh_ok
    s_and_b32 s24, vcc_lo, s46
    s_cmp_eq_u32 s24, s46
    s_cbranch_scc1 g2_wh_ok
    s_sleep 1
    s_branch g2_wh
g2_wh_ok:
    s_and_b32 s24, vcc_lo, 0x7fff
    s_cmp_eq_u32 s24, 0x7fff
    s_cselect_b32 s101, s101, s41
    s_add_u32 s100, s41, 28672
g2_hready:
    s_barrier
    s_add_u32 m0, s98, 0
    s_nop 0
    buffer_load_dwordx4 v2, s[16:19], s42 offen sc1 lds
    buffer_load_dwordx4 v3, s[16:19], s42 offen offset:1024 sc1 lds
    s_add_u32 s42, s42, 128
    s_sub_u32 s25, s42, 1792
    s_cmp_ge_u32 s42, s43
    s_cselect_b32 s42, s25, s42
    s_add_u32 m0, s98, 8192
    s_nop 0
    buffer_load_dwordx4 v2, s[16:19], s42 offen sc1 lds
    buffer_load_dwordx4 v3, s[16:19], s42 offen offset:1024 sc1 lds
    s_add_u32 s42, s42, 128
    s_sub_u32 s25, s42, 1792
    s_cmp_ge_u32 s42, s43
    s_cselect_b32 s42, s25, s42
    s_add_u32 m0, s98, 16384
    s_nop 0
    buffer_load_dwordx4 v2, s[16:19], s42 offen sc1 lds
    buffer_load_dwordx4 v3, s[16:19], s42 offen offset:1024 sc1 lds
    s_add_u32 s42, s42, 128
    s_sub_u32 s25, s42, 1792
    s_cmp_ge_u32 s42, s43
    s_cselect_b32 s42, s25, s42
    s_add_u32 m0, s98, 24576
    s_nop 0
    buffer_load_dwordx4 v2, s[16:19], s42 offen sc1 lds
    buffer_load_dwordx4 v3, s[16:19], s42 offen offset:1024 sc1 lds
    s_add_u32 s42, s42, 128
    s_sub_u32 s25, s42, 1792
    s_cmp_ge_u32 s42, s43
    s_cselect_b32 s42, s25, s42
    s_add_u32 m0, s98, 32768
    s_nop 0
    buffer_load_dwordx4 v2, s[16:19], s42 offen sc1 lds
    buffer_load_dwordx4 v3, s[16:19], s42 offen offset:1024 sc1 lds
    s_add_u32 s42, s42, 128
    s_sub_u32 s25, s42, 1792
    s_cmp_ge_u32 s42, s43
    s_cselect_b32 s42, s25, s42
    v_and_b32 v22, 31, v0
    v_lshlrev_b32 v22, 2, v22
    s_add_u32 s33, s41, 28672
    s_waitcnt vmcnt(8)
    s_barrier
    ds_read_b128 v[32:35], v5 offset:0
    ds_read_b128 v[36:39], v5 offset:4096
    s_waitcnt lgkmcnt(0)
    s_waitcnt vmcnt(6)
    s_barrier
    s_add_u32 m0, s98, 40960
    s_nop 0
    buffer_load_dwordx4 v2, s[16:19], s42 offen sc1 lds
    buffer_load_dwordx4 v3, s[16:19], s42 offen offset:1024 sc1 lds
    s_add_u32 s42, s42, 128
    s_sub_u32 s25, s42, 1792
    s_cmp_ge_u32 s42, s43
    s_cselect_b32 s42, s25, s42
    ds_read_b128 v[48:51], v5 offset:8192
    ds_read_b128 v[52:55], v5 offset:12288
    v_mfma_f32_32x32x16_bf16 v[64:79], v[128:131], v[32:35], 0
    s_add_u32 m0, s98, 49152
    s_nop 0
    buffer_load_dwordx4 v2, s[16:19], s42 offen sc1 lds
    buffer_load_dwordx4 v3, s[16:19], s42 offen offset:1024 sc1 lds
    s_add_u32 s42, s42, 128
    s_sub_u32 s25, s42, 1792
    s_cmp_ge_u32 s42, s43
    s_cselect_b32 s42, s25, s42
    v_mfma_f32_32x32x16_bf16 v[80:95], v[128:131], v[36:39], 0
    s_add_u32 m0, s98, 57344
    s_nop 0
    buffer_load_dwordx4 v2, s[16:19], s42 offen sc1 lds
    v_mfma_f32_32x32x16_bf16 v[96:111], v[132:135], v[32:35], 0
    buffer_load_dwordx4 v3, s[16:19], s42 offen offset:1024 sc1 lds
    s_add_u32 s42, s42, 128
    s_sub_u32 s25, s42, 1792
    s_cmp_ge_u32 s42, s43
    s_cselect_b32 s42, s25, s42
    v_mfma_f32_32x32x16_bf16 v[112:127], v[132:135], v[36:39], 0
    s_waitcnt lgkmcnt(0)
    s_waitcnt vmcnt(10)
    s_barrier
    s_add_u32 m0, s98, 65536
    s_nop 0
    buffer_load_dwordx4 v2, s[16:19], s42 offen sc1 lds
    buffer_load_dwordx4 v3, s[16:19], s42 offen offset:1024 sc1 lds
    s_add_u32 s42, s42, 128
    s_sub_u32 s25, s42, 1792
    s_cmp_ge_u32 s42, s43
    s_cselect_b32 s42, s25, s42
    ds_read_b128 v[32:35], v5 offset:16384
    ds_read_b128 v[36:39], v5 offset:20480
    v_mfma_f32_32x32x16_bf16 v[64:79], v[136:139], v[48:51], v[64:79]
    s_add_u32 m0, s98, 73728
    s_nop 0
    buffer_load_dwordx4 v2, s[16:19], s42 offen sc1 lds
    buffer_load_dwordx4 v3, s[16:19], s42 offen offset:1024 sc1 lds
    s_add_u32 s42, s42, 128
    s_sub_u32 s25, s42, 1792
    s_cmp_ge_u32 s42, s43
    s_cselect_b32 s42, s25, s42
    v_mfma_f32_32x32x16_bf16 v[80:95], v[136:139], v[52:55], v[80:95]
    s_add_u32 m0, s98, 0
    s_nop 0
    buffer_load_dwordx4 v2, s[16:19], s42 offen sc1 lds
    v_mfma_f32_32x32x16_bf16 v[96:111], v[140:143], v[48:51], v[96:111]
    buffer_load_dwordx4 v3, s[16:19], s42 offen offset:1024 sc1 lds
    s_add_u32 s42, s42, 128
    s_sub_u32 s25, s42, 1792
    s_cmp_ge_u32 s42, s43
    s_cselect_b32 s42, s25, s42
    v_mfma_f32_32x32x16_bf16 v[112:127], v[140:143], v[52:55], v[112:127]
    s_waitcnt lgkmcnt(0)
    s_waitcnt vmcnt(14)
    s_barrier
    s_add_u32 m0, s98, 8192
    s_nop 0
    buffer_load_dwordx4 v2, s[16:19], s42 offen sc1 lds
    ds_read_b128 v[48:51], v5 offset:24576
    ds_read_b128 v[52:55], v5 offset:28672
    v_mfma_f32_32x32x16_bf16 v[64:79], v[144:147], v[32:35], v[64:79]
    buffer_load_dwordx4 v3, s[16:19], s42 offen offset:1024 sc1 lds
    s_add_u32 s42, s42, 128
    s_sub_u32 s25, s42, 1792
    s_cmp_ge_u32 s42, s43
    s_cselect_b32 s42, s25, s42
    v_mfma_f32_32x32x16_bf16 v[80:95], v[144:147], v[36:39], v[80:95]
    s_add_u32 m0, s98, 16384
    s_nop 0
    buffer_load_dwordx4 v2, s[16:19], s42 offen sc1 lds
    v_mfma_f32_32x32x16_bf16 v[96:111], v[148:151], v[32:35], v[96:111]
    buffer_load_dwordx4 v3, s[16:19], s42 offen offset:1024 sc1 lds
    s_add_u32 s42, s42, 128
    s_sub_u32 s25, s42, 1792
    s_cmp_ge_u32 s42, s43
    s_cselect_b32 s42, s25, s42
    v_mfma_f32_32x32x16_bf16 v[112:127], v[148:151], v[36:39], v[112:127]
    s_waitcnt lgkmcnt(0)
    s_waitcnt vmcnt(16)
    s_barrier
    s_add_u32 m0, s98, 24576
    s_nop 0
    buffer_load_dwordx4 v2, s[16:19], s42 offen sc1 lds
    ds_read_b128 v[32:35], v5 offset:32768
    ds_read_b128 v[36:39], v5 offset:36864
    v_mfma_f32_32x32x16_bf16 v[64:79], v[152:155], v[48:51], v[64:79]
    buffer_load_dwordx4 v3, s[16:19], s42 offen offset:1024 sc1 lds
    s_sub_u32 s25, 28, s39
    s_mul_i32 s25, s25, 128
    s_add_u32 s43, s40, s25
    s_sub_u32 s25, 14, s39
    s_add_u32 s25, s25, s38
    s_mul_i32 s25, s25, 128
    s_add_u32 s42, s40, s25
    v_mfma_f32_32x32x16_bf16 v[80:95], v[152:155], v[52:55], v[80:95]
    v_mfma_f32_32x32x16_bf16 v[96:111], v[156:159], v[48:51], v[96:111]
    v_mfma_f32_32x32x16_bf16 v[112:127], v[156:159], v[52:55], v[112:127]
    s_waitcnt lgkmcnt(0)
    s_waitcnt vmcnt(16)
    s_barrier
    buffer_load_dword v21, v22, s[48:51], s101 offen sc1
    s_add_u32 m0, s98, 32768
    s_nop 0
    buffer_load_dwordx4 v20, s[92:95], s96 offen lds
    ds_read_b128 v[48:51], v5 offset:40960
    ds_read_b128 v[52:55], v5 offset:45056
    v_mfma_f32_32x32x16_bf16 v[64:79], v[160:163], v[32:35], v[64:79]
    buffer_load_dwordx4 v19, s[92:95], s96 offen offset:1024 lds
    s_add_u32 s96, s96, 57344
    s_sub_u32 s99, s96, 802816
    s_cmp_ge_u32 s96, s97
    s_cselect_b32 s96, s99, s96
    v_mfma_f32_32x32x16_bf16 v[80:95], v[160:163], v[36:39], v[80:95]
    v_mfma_f32_32x32x16_bf16 v[96:111], v[164:167], v[32:35], v[96:111]
    v_mfma_f32_32x32x16_bf16 v[112:127], v[164:167], v[36:39], v[112:127]
    s_waitcnt lgkmcnt(0)
    s_waitcnt vmcnt(17)
    s_barrier
    s_add_u32 m0, s98, 40960
    s_nop 0
    buffer_load_dwordx4 v20, s[92:95], s96 offen lds
    ds_read_b128 v[32:35], v5 offset:49152
    ds_read_b128 v[36:39], v5 offset:53248
    v_mfma_f32_32x32x16_bf16 v[64:79], v[168:171], v[48:51], v[64:79]
    buffer_load_dwordx4 v19, s[92:95], s96 offen offset:1024 lds
    s_add_u32 s96, s96, 57344
    s_sub_u32 s99, s96, 802816
    s_cmp_ge_u32 s96, s97
    s_cselect_b32 s96, s99, s96
    v_mfma_f32_32x32x16_bf16 v[80:95], v[168:171], v[52:55], v[80:95]
    v_mfma_f32_32x32x16_bf16 v[96:111], v[172:175], v[48:51], v[96:111]
    v_mfma_f32_32x32x16_bf16 v[112:127], v[172:175], v[52:55], v[112:127]
    s_waitcnt lgkmcnt(0)
    s_waitcnt vmcnt(17)
    s_barrier
    s_add_u32 m0, s98, 49152
    s_nop 0
    buffer_load_dwordx4 v20, s[92:95], s96 offen lds
    ds_read_b128 v[48:51], v5 offset:57344
    ds_read_b128 v[52:55], v5 offset:61440
    v_mfma_f32_32x32x16_bf16 v[64:79], v[176:179], v[32:35], v[64:79]
    buffer_load_dwordx4 v19, s[92:95], s96 offen offset:1024 lds
    s_add_u32 s96, s96, 57344
    s_sub_u32 s99, s96, 802816
    s_cmp_ge_u32 s96, s97
    s_cselect_b32 s96, s99, s96
    v_mfma_f32_32x32x16_bf16 v[80:95], v[176:179], v[36:39], v[80:95]
    v_mfma_f32_32x32x16_bf16 v[96:111], v[180:183], v[32:35], v[96:111]
    v_mfma_f32_32x32x16_bf16 v[112:127], v[180:183], v[36:39], v[112:127]
    s_waitcnt lgkmcnt(0)
    s_waitcnt vmcnt(17)
    s_barrier
    s_add_u32 m0, s98, 57344
    s_nop 0
    buffer_load_dwordx4 v20, s[92:95], s96 offen lds
    ds_read_b128 v[32:35], v16 offset:0
    ds_read_b128 v[36:39], v16 offset:4096
    v_mfma_f32_32x32x16_bf16 v[64:79], v[184:187], v[48:51], v[64:79]
    buffer_load_dwordx4 v19, s[92:95], s96 offen offset:1024 lds
    s_add_u32 s96, s96, 57344
    s_sub_u32 s99, s96, 802816
    s_cmp_ge_u32 s96, s97
    s_cselect_b32 s96, s99, s96
    v_mfma_f32_32x32x16_bf16 v[80:95], v[184:187], v[52:55], v[80:95]
    v_mfma_f32_32x32x16_bf16 v[96:111], v[188:191], v[48:51], v[96:111]
    v_mfma_f32_32x32x16_bf16 v[112:127], v[188:191], v[52:55], v[112:127]
    s_waitcnt lgkmcnt(0)
    s_waitcnt vmcnt(17)
    s_mov_b32 s35, 0x7fff
    s_cmp_eq_u32 s101, 114688
    s_cbranch_scc1 g2_wh2_done
    s_waitcnt vmcnt(8)
    v_cmp_eq_u32 vcc, s37, v21
    s_nop 2
    s_and_b32 s24, vcc_lo, 0x7fff
    s_cmp_eq_u32 s24, 0x7fff
    s_cbranch_scc1 g2_wh2_done
    v_and_b32 v10, 31, v0
    v_lshlrev_b32 v10, 2, v10
    s_mov_b32 s34, 0
g2_wh2:
    buffer_load_dword v11, v10, s[48:51], s41 offen sc1
    s_waitcnt vmcnt(0)
    v_cmp_eq_u32 vcc, s37, v11
    s_add_u32 s34, s34, 1
    s_cmp_ge_u32 s34, 400000
    s_cbranch_scc1 g2_wh2_ok
    s_and_b32 s24, vcc_lo, s35
    s_cmp_eq_u32 s24, s35
    s_cbranch_scc1 g2_wh2_ok
    s_sleep 1
    s_branch g2_wh2
g2_wh2_ok:
g2_wh2_done:
    s_barrier
    s_add_u32 m0, s98, 65536
    s_nop 0
    buffer_load_dwordx4 v2, s[16:19], s42 offen sc1 lds
    ds_read_b128 v[48:51], v16 offset:8192
    ds_read_b128 v[52:55], v16 offset:12288
    v_mfma_f32_32x32x16_bf16 v[64:79], v[192:195], v[32:35], v[64:79]
    buffer_load_dwordx4 v3, s[16:19], s42 offen offset:1024 sc1 lds
    s_add_u32 s42, s42, 128
    s_sub_u32 s25, s42, 1792
    s_cmp_ge_u32 s42, s43
    s_cselect_b32 s42, s25, s42
    v_mfma_f32_32x32x16_bf16 v[80:95], v[192:195], v[36:39], v[80:95]
    v_mfma_f32_32x32x16_bf16 v[96:111], v[196:199], v[32:35], v[96:111]
    v_mfma_f32_32x32x16_bf16 v[112:127], v[196:199], v[36:39], v[112:127]
    s_waitcnt lgkmcnt(0)
    s_waitcnt vmcnt(17)
    s_barrier
    s_add_u32 m0, s98, 73728
    s_nop 0
    buffer_load_dwordx4 v2, s[16:19], s42 offen sc1 lds
    ds_read_b128 v[32:35], v5 offset:0
    ds_read_b128 v[36:39], v5 offset:4096
    v_mfma_f32_32x32x16_bf16 v[64:79], v[200:203], v[48:51], v[64:79]
    buffer_load_dwordx4 v3, s[16:19], s42 offen offset:1024 sc1 lds
    s_add_u32 s42, s42, 128
    s_sub_u32 s25, s42, 1792
    s_cmp_ge_u32 s42, s43
    s_cselect_b32 s42, s25, s42
    v_mfma_f32_32x32x16_bf16 v[80:95], v[200:203], v[52:55], v[80:95]
    v_mfma_f32_32x32x16_bf16 v[96:111], v[204:207], v[48:51], v[96:111]
    v_mfma_f32_32x32x16_bf16 v[112:127], v[204:207], v[52:55], v[112:127]
    s_waitcnt lgkmcnt(0)
    s_waitcnt vmcnt(17)
    s_barrier
    s_add_u32 m0, s98, 0
    s_nop 0
    buffer_load_dwordx4 v2, s[16:19], s42 offen sc1 lds
    ds_read_b128 v[48:51], v5 offset:8192
    ds_read_b128 v[52:55], v5 offset:12288
    v_mfma_f32_32x32x16_bf16 v[64:79], v[208:211], v[32:35], v[64:79]
    buffer_load_dwordx4 v3, s[16:19], s42 offen offset:1024 sc1 lds
    s_add_u32 s42, s42, 128
    s_sub_u32 s25, s42, 1792
    s_cmp_ge_u32 s42, s43
    s_cselect_b32 s42, s25, s42
    v_mfma_f32_32x32x16_bf16 v[80:95], v[208:211], v[36:39], v[80:95]
    v_mfma_f32_32x32x16_bf16 v[96:111], v[212:215], v[32:35], v[96:111]
    v_mfma_f32_32x32x16_bf16 v[112:127], v[212:215], v[36:39], v[112:127]
    s_waitcnt lgkmcnt(0)
    s_waitcnt vmcnt(17)
    s_barrier
    s_add_u32 m0, s98, 8192
    s_nop 0
    buffer_load_dwordx4 v2, s[16:19], s42 offen sc1 lds
    ds_read_b128 v[32:35], v5 offset:16384
    ds_read_b128 v[36:39], v5 offset:20480
    v_mfma_f32_32x32x16_bf16 v[64:79], v[216:219], v[48:51], v[64:79]
    buffer_load_dwordx4 v3, s[16:19], s42 offen offset:1024 sc1 lds
    s_add_u32 s42, s42, 128
    s_sub_u32 s25, s42, 1792
    s_cmp_ge_u32 s42, s43
    s_cselect_b32 s42, s25, s42
    v_mfma_f32_32x32x16_bf16 v[80:95], v[216:219], v[52:55], v[80:95]
    v_mfma_f32_32x32x16_bf16 v[96:111], v[220:223], v[48:51], v[96:111]
    v_mfma_f32_32x32x16_bf16 v[112:127], v[220:223], v[52:55], v[112:127]
    s_waitcnt lgkmcnt(0)
    s_waitcnt vmcnt(17)
    s_barrier
    s_add_u32 s8, s28, 9175040
    s_addc_u32 s9, s29, 0
    s_mov_b32 s10, 1835008
    s_mov_b32 s11, 0x20000
    s_mov_b32 s12, s30
    s_mov_b32 s13, s31
    s_mov_b32 s14, 1835008
    s_mov_b32 s15, 0x20000
    s_add_u32 s20, s28, 14811136
    s_addc_u32 s21, s29, 0
    s_mov_b32 s22, 8192
    s_mov_b32 s23, 0x20000
    s_add_u32 m0, s98, 16384
    s_nop 0
    buffer_load_dwordx4 v2, s[16:19], s42 offen sc1 lds
    ds_read_b128 v[48:51], v5 offset:24576
    ds_read_b128 v[52:55], v5 offset:28672
    v_mfma_f32_32x32x16_bf16 v[64:79], v[224:227], v[32:35], v[64:79]
    buffer_load_dwordx4 v3, s[16:19], s42 offen offset:1024 sc1 lds
    s_add_u32 s42, s42, 128
    s_sub_u32 s25, s42, 1792
    s_cmp_ge_u32 s42, s43
    s_cselect_b32 s42, s25, s42
    v_mfma_f32_32x32x16_bf16 v[80:95], v[224:227], v[36:39], v[80:95]
    v_mfma_f32_32x32x16_bf16 v[96:111], v[228:231], v[32:35], v[96:111]
    v_mfma_f32_32x32x16_bf16 v[112:127], v[228:231], v[36:39], v[112:127]
    s_waitcnt lgkmcnt(0)
    s_waitcnt vmcnt(8)
    s_barrier
    s_add_u32 m0, s98, 24576
    s_nop 0
    buffer_load_dwordx4 v2, s[16:19], s42 offen sc1 lds
    ds_read_b128 v[32:35], v16 offset:0
    ds_read_b128 v[36:39], v16 offset:4096
    v_mfma_f32_32x32x16_bf16 v[64:79], v[232:235], v[48:51], v[64:79]
    buffer_load_dwordx4 v3, s[16:19], s42 offen offset:1024 sc1 lds
    s_add_u32 s42, s42, 128
    s_sub_u32 s25, s42, 1792
    s_cmp_ge_u32 s42, s43
    s_cselect_b32 s42, s25, s42
    v_mfma_f32_32x32x16_bf16 v[80:95], v[232:235], v[52:55], v[80:95]
    v_mfma_f32_32x32x16_bf16 v[96:111], v[236:239], v[48:51], v[96:111]
    v_mfma_f32_32x32x16_bf16 v[112:127], v[236:239], v[52:55], v[112:127]
    s_waitcnt lgkmcnt(0)
    s_waitcnt vmcnt(8)
    s_barrier
    s_add_u32 m0, s98, 65536
    s_nop 0
    buffer_load_dwordx4 v2, s[16:19], s42 offen sc1 lds
    ds_read_b128 v[48:51], v16 offset:8192
    ds_read_b128 v[52:55], v16 offset:12288
    v_mfma_f32_32x32x16_bf16 v[64:79], v[240:243], v[32:35], v[64:79]
    buffer_load_dwordx4 v3, s[16:19], s42 offen offset:1024 sc1 lds
    s_add_u32 s42, s42, 128
    s_sub_u32 s25, s42, 1792
    s_cmp_ge_u32 s42, s43
    s_cselect_b32 s42, s25, s42
    v_mfma_f32_32x32x16_bf16 v[80:95], v[240:243], v[36:39], v[80:95]
    v_mfma_f32_32x32x16_bf16 v[96:111], v[244:247], v[32:35], v[96:111]
    v_mfma_f32_32x32x16_bf16 v[112:127], v[244:247], v[36:39], v[112:127]
    s_waitcnt lgkmcnt(0)
    s_waitcnt vmcnt(8)
    s_barrier
    s_add_u32 m0, s98, 73728
    s_nop 0
    buffer_load_dwordx4 v20, s[92:95], s96 offen lds
    ds_read_b128 v[32:35], v5 offset:0
    ds_read_b64_tr_b16 v[24:25], v6 offset:32768
    v_mfma_f32_32x32x16_bf16 v[64:79], v[248:251], v[48:51], v[64:79]
    buffer_load_dwordx4 v19, s[92:95], s96 offen offset:1024 lds
    s_add_u32 s96, s96, 57344
    s_sub_u32 s99, s96, 802816
    s_cmp_ge_u32 s96, s97
    s_cselect_b32 s96, s99, s96
    ds_read_b64_tr_b16 v[26:27], v6 offset:33280
    ds_read_b128 v[36:39], v5 offset:4096
    v_mfma_f32_32x32x16_bf16 v[80:95], v[248:251], v[52:55], v[80:95]
    ds_read_b64_tr_b16 v[28:29], v7 offset:32768
    ds_read_b64_tr_b16 v[30:31], v7 offset:33280
    v_mfma_f32_32x32x16_bf16 v[96:111], v[252:255], v[48:51], v[96:111]
    v_mfma_f32_32x32x16_bf16 v[112:127], v[252:255], v[52:55], v[112:127]
    s_waitcnt lgkmcnt(0)
    s_waitcnt vmcnt(8)
    s_barrier
    s_add_u32 m0, s98, 0
    s_nop 0
    buffer_load_dwordx4 v2, s[16:19], s42 offen sc1 lds
    ds_read_b128 v[48:51], v5 offset:8192
    ds_read_b64_tr_b16 v[40:41], v6 offset:40960
    v_mfma_f32_32x32x16_bf16 v[64:79], v[24:27], v[32:35], v[64:79]
    buffer_load_dwordx4 v3, s[16:19], s42 offen offset:1024 sc1 lds
    s_add_u32 s42, s42, 128
    s_sub_u32 s25, s42, 1792
    s_cmp_ge_u32 s42, s43
    s_cselect_b32 s42, s25, s42
    ds_read_b64_tr_b16 v[42:43], v6 offset:41472
    ds_read_b128 v[52:55], v5 offset:12288
    v_mfma_f32_32x32x16_bf16 v[80:95], v[24:27], v[36:39], v[80:95]
    s_add_u32 m0, s98, 32768
    s_nop 0
    buffer_load_dwordx4 v20, s[92:95], s96 offen lds
    ds_read_b64_tr_b16 v[44:45], v7 offset:40960
    ds_read_b64_tr_b16 v[46:47], v7 offset:41472
    v_mfma_f32_32x32x16_bf16 v[96:111], v[28:31], v[32:35], v[96:111]
    buffer_load_dwordx4 v19, s[92:95], s96 offen offset:1024 lds
    s_add_u32 s96, s96, 57344
    s_sub_u32 s99, s96, 802816
    s_cmp_ge_u32 s96, s97
    s_cselect_b32 s96, s99, s96
    v_mfma_f32_32x32x16_bf16 v[112:127], v[28:31], v[36:39], v[112:127]
    s_waitcnt lgkmcnt(0)
    s_waitcnt vmcnt(10)
    s_barrier
    s_add_u32 m0, s98, 8192
    s_nop 0
    buffer_load_dwordx4 v2, s[16:19], s42 offen sc1 lds
    ds_read_b128 v[32:35], v5 offset:16384
    ds_read_b64_tr_b16 v[24:25], v6 offset:49152
    v_mfma_f32_32x32x16_bf16 v[64:79], v[40:43], v[48:51], v[64:79]
    buffer_load_dwordx4 v3, s[16:19], s42 offen offset:1024 sc1 lds
    s_add_u32 s42, s42, 128
    s_sub_u32 s25, s42, 1792
    s_cmp_ge_u32 s42, s43
    s_cselect_b32 s42, s25, s42
    ds_read_b64_tr_b16 v[26:27], v6 offset:49664
    ds_read_b128 v[36:39], v5 offset:20480
    v_mfma_f32_32x32x16_bf16 v[80:95], v[40:43], v[52:55], v[80:95]
    s_add_u32 m0, s98, 40960
    s_nop 0
    buffer_load_dwordx4 v20, s[92:95], s96 offen lds
    ds_read_b64_tr_b16 v[28:29], v7 offset:49152
    ds_read_b64_tr_b16 v[30:31], v7 offset:49664
    v_mfma_f32_32x32x16_bf16 v[96:111], v[44:47], v[48:51], v[96:111]
    buffer_load_dwordx4 v19, s[92:95], s96 offen offset:1024 lds
    s_add_u32 s96, s96, 57344
    s_sub_u32 s99, s96, 802816
    s_cmp_ge_u32 s96, s97
    s_cselect_b32 s96, s99, s96
    v_mfma_f32_32x32x16_bf16 v[112:127], v[44:47], v[52:55], v[112:127]
    s_waitcnt lgkmcnt(0)
    s_waitcnt vmcnt(12)
    s_barrier
    s_add_u32 m0, s98, 16384
    s_nop 0
    buffer_load_dwordx4 v2, s[16:19], s42 offen sc1 lds
    ds_read_b128 v[48:51], v5 offset:24576
    ds_read_b64_tr_b16 v[40:41], v6 offset:57344
    v_mfma_f32_32x32x16_bf16 v[64:79], v[24:27], v[32:35], v[64:79]
    buffer_load_dwordx4 v3, s[16:19], s42 offen offset:1024 sc1 lds
    s_add_u32 s42, s42, 128
    s_sub_u32 s25, s42, 1792
    s_cmp_ge_u32 s42, s43
    s_cselect_b32 s42, s25, s42
    ds_read_b64_tr_b16 v[42:43], v6 offset:57856
    ds_read_b128 v[52:55], v5 offset:28672
    v_mfma_f32_32x32x16_bf16 v[80:95], v[24:27], v[36:39], v[80:95]
    s_add_u32 m0, s98, 49152
    s_nop 0
    buffer_load_dwordx4 v20, s[92:95], s96 offen lds
    ds_read_b64_tr_b16 v[44:45], v7 offset:57344
    ds_read_b64_tr_b16 v[46:47], v7 offset:57856
    v_mfma_f32_32x32x16_bf16 v[96:111], v[28:31], v[32:35], v[96:111]
    buffer_load_dwordx4 v19, s[92:95], s96 offen offset:1024 lds
    s_add_u32 s96, s96, 57344
    s_sub_u32 s99, s96, 802816
    s_cmp_ge_u32 s96, s97
    s_cselect_b32 s96, s99, s96
    v_mfma_f32_32x32x16_bf16 v[112:127], v[28:31], v[36:39], v[112:127]
    s_waitcnt lgkmcnt(0)
    s_waitcnt vmcnt(12)
    s_barrier
    s_add_u32 m0, s98, 24576
    s_nop 0
    buffer_load_dwordx4 v2, s[16:19], s42 offen sc1 lds
    ds_read_b128 v[32:35], v16 offset:0
    ds_read_b64_tr_b16 v[24:25], v17 offset:8192
    v_mfma_f32_32x32x16_bf16 v[64:79], v[40:43], v[48:51], v[64:79]
    buffer_load_dwordx4 v3, s[16:19], s42 offen offset:1024 sc1 lds
    s_add_u32 s42, s42, 128
    s_sub_u32 s25, s42, 1792
    s_cmp_ge_u32 s42, s43
    s_cselect_b32 s42, s25, s42
    ds_read_b64_tr_b16 v[26:27], v17 offset:8704
    ds_read_b128 v[36:39], v16 offset:4096
    v_mfma_f32_32x32x16_bf16 v[80:95], v[40:43], v[52:55], v[80:95]
    s_add_u32 m0, s98, 57344
    s_nop 0
    buffer_load_dwordx4 v20, s[92:95], s96 offen lds
    ds_read_b64_tr_b16 v[28:29], v18 offset:8192
    ds_read_b64_tr_b16 v[30:31], v18 offset:8704
    v_mfma_f32_32x32x16_bf16 v[96:111], v[44:47], v[48:51], v[96:111]
    buffer_load_dwordx4 v19, s[92:95], s96 offen offset:1024 lds
    s_add_u32 s96, s96, 57344
    s_sub_u32 s99, s96, 802816
    s_cmp_ge_u32 s96, s97
    s_cselect_b32 s96, s99, s96
    v_mfma_f32_32x32x16_bf16 v[112:127], v[44:47], v[52:55], v[112:127]
    s_waitcnt lgkmcnt(0)
    s_waitcnt vmcnt(12)
    s_barrier
    buffer_load_dword v21, v22, s[48:51], s100 offen sc1
    s_add_u32 m0, s98, 65536
    s_nop 0
    buffer_load_dwordx4 v2, s[16:19], s42 offen sc1 lds
    ds_read_b128 v[48:51], v5 offset:0
    ds_read_b64_tr_b16 v[40:41], v6 offset:32768
    v_mfma_f32_32x32x16_bf16 v[64:79], v[24:27], v[32:35], v[64:79]
    buffer_load_dwordx4 v3, s[16:19], s42 offen offset:1024 sc1 lds
    s_add_u32 s42, s42, 128
    s_sub_u32 s25, s42, 1792
    s_cmp_ge_u32 s42, s43
    s_cselect_b32 s42, s25, s42
    ds_read_b64_tr_b16 v[42:43], v6 offset:33280
    ds_read_b128 v[52:55], v5 offset:4096
    v_mfma_f32_32x32x16_bf16 v[80:95], v[24:27], v[36:39], v[80:95]
    s_add_u32 m0, s98, 73728
    s_nop 0
    buffer_load_dwordx4 v20, s[92:95], s96 offen lds
    ds_read_b64_tr_b16 v[44:45], v7 offset:32768
    ds_read_b64_tr_b16 v[46:47], v7 offset:33280
    v_mfma_f32_32x32x16_bf16 v[96:111], v[28:31], v[32:35], v[96:111]
    buffer_load_dwordx4 v19, s[92:95], s96 offen offset:1024 lds
    s_add_u32 s96, s96, 57344
    s_sub_u32 s99, s96, 802816
    s_cmp_ge_u32 s96, s97
    s_cselect_b32 s96, s99, s96
    v_mfma_f32_32x32x16_bf16 v[112:127], v[28:31], v[36:39], v[112:127]
    s_waitcnt lgkmcnt(0)
    s_waitcnt vmcnt(13)
    s_barrier
    s_add_u32 m0, s98, 0
    s_nop 0
    buffer_load_dwordx4 v2, s[16:19], s42 offen sc1 lds
    ds_read_b128 v[32:35], v5 offset:8192
    ds_read_b64_tr_b16 v[24:25], v6 offset:40960
    v_mfma_f32_32x32x16_bf16 v[64:79], v[40:43], v[48:51], v[64:79]
    buffer_load_dwordx4 v3, s[16:19], s42 offen offset:1024 sc1 lds
    s_add_u32 s42, s42, 128
    s_sub_u32 s25, s42, 1792
    s_cmp_ge_u32 s42, s43
    s_cselect_b32 s42, s25, s42
    ds_read_b64_tr_b16 v[26:27], v6 offset:41472
    ds_read_b128 v[36:39], v5 offset:12288
    v_mfma_f32_32x32x16_bf16 v[80:95], v[40:43], v[52:55], v[80:95]
    s_add_u32 m0, s98, 32768
    s_nop 0
    buffer_load_dwordx4 v20, s[92:95], s96 offen lds
    ds_read_b64_tr_b16 v[28:29], v7 offset:40960
    ds_read_b64_tr_b16 v[30:31], v7 offset:41472
    v_mfma_f32_32x32x16_bf16 v[96:111], v[44:47], v[48:51], v[96:111]
    buffer_load_dwordx4 v19, s[92:95], s96 offen offset:1024 lds
    s_add_u32 s96, s96, 57344
    s_sub_u32 s99, s96, 802816
    s_cmp_ge_u32 s96, s97
    s_cselect_b32 s96, s99, s96
    v_mfma_f32_32x32x16_bf16 v[112:127], v[44:47], v[52:55], v[112:127]
    s_waitcnt lgkmcnt(0)
    s_waitcnt vmcnt(13)
    s_barrier
    s_add_u32 m0, s98, 8192
    s_nop 0
    buffer_load_dwordx4 v2, s[16:19], s42 offen sc1 lds
    ds_read_b128 v[48:51], v5 offset:16384
    ds_read_b64_tr_b16 v[40:41], v6 offset:49152
    v_mfma_f32_32x32x16_bf16 v[64:79], v[24:27], v[32:35], v[64:79]
    buffer_load_dwordx4 v3, s[16:19], s42 offen offset:1024 sc1 lds
    s_add_u32 s42, s42, 128
    s_sub_u32 s25, s42, 1792
    s_cmp_ge_u32 s42, s43
    s_cselect_b32 s42, s25, s42
    ds_read_b64_tr_b16 v[42:43], v6 offset:49664
    ds_read_b128 v[52:55], v5 offset:20480
    v_mfma_f32_32x32x16_bf16 v[80:95], v[24:27], v[36:39], v[80:95]
    s_add_u32 m0, s98, 40960
    s_nop 0
    buffer_load_dwordx4 v20, s[92:95], s96 offen lds
    ds_read_b64_tr_b16 v[44:45], v7 offset:49152
    ds_read_b64_tr_b16 v[46:47], v7 offset:49664
    v_mfma_f32_32x32x16_bf16 v[96:111], v[28:31], v[32:35], v[96:111]
    buffer_load_dwordx4 v19, s[92:95], s96 offen offset:1024 lds
    s_add_u32 s96, s96, 57344
    s_sub_u32 s99, s96, 802816
    s_cmp_ge_u32 s96, s97
    s_cselect_b32 s96, s99, s96
    v_mfma_f32_32x32x16_bf16 v[112:127], v[28:31], v[36:39], v[112:127]
    s_waitcnt lgkmcnt(0)
    s_waitcnt vmcnt(13)
    s_barrier
    ds_read_b128 v[32:35], v5 offset:24576
    ds_read_b64_tr_b16 v[24:25], v6 offset:57344
    v_mfma_f32_32x32x16_bf16 v[64:79], v[40:43], v[48:51], v[64:79]
    ds_read_b64_tr_b16 v[26:27], v6 offset:57856
    ds_read_b128 v[36:39], v5 offset:28672
    v_mfma_f32_32x32x16_bf16 v[80:95], v[40:43], v[52:55], v[80:95]
    ds_read_b64_tr_b16 v[28:29], v7 offset:57344
    ds_read_b64_tr_b16 v[30:31], v7 offset:57856
    v_mfma_f32_32x32x16_bf16 v[96:111], v[44:47], v[48:51], v[96:111]
    v_mfma_f32_32x32x16_bf16 v[112:127], v[44:47], v[52:55], v[112:127]
    s_waitcnt lgkmcnt(0)
    s_waitcnt vmcnt(8)
    s_barrier
    ds_read_b128 v[48:51], v16 offset:0
    ds_read_b64_tr_b16 v[40:41], v17 offset:8192
    v_mfma_f32_32x32x16_bf16 v[64:79], v[24:27], v[32:35], v[64:79]
    ds_read_b64_tr_b16 v[42:43], v17 offset:8704
    ds_read_b128 v[52:55], v16 offset:4096
    v_mfma_f32_32x32x16_bf16 v[80:95], v[24:27], v[36:39], v[80:95]
    ds_read_b64_tr_b16 v[44:45], v18 offset:8192
    ds_read_b64_tr_b16 v[46:47], v18 offset:8704
    v_mfma_f32_32x32x16_bf16 v[96:111], v[28:31], v[32:35], v[96:111]
    v_mfma_f32_32x32x16_bf16 v[112:127], v[28:31], v[36:39], v[112:127]
    s_waitcnt lgkmcnt(0)
    s_waitcnt vmcnt(4)
    s_mov_b32 s35, 0xffffffff
    s_cmp_eq_u32 s100, 114688
    s_cbranch_scc1 g2_wa_done
    s_waitcnt vmcnt(12)
    v_cmp_eq_u32 vcc, s37, v21
    s_nop 2
    s_and_b32 s24, vcc_lo, 0xffffffff
    s_cmp_eq_u32 s24, 0xffffffff
    s_cbranch_scc1 g2_wa_done
    v_and_b32 v10, 31, v0
    v_lshlrev_b32 v10, 2, v10
    s_mov_b32 s34, 0
g2_wa:
    buffer_load_dword v11, v10, s[48:51], s33 offen sc1
    s_waitcnt vmcnt(0)
    v_cmp_eq_u32 vcc, s37, v11
    s_add_u32 s34, s34, 1
    s_cmp_ge_u32 s34, 400000
    s_cbranch_scc1 g2_wa_ok
    s_and_b32 s24, vcc_lo, s35
    s_cmp_eq_u32 s24, s35
    s_cbranch_scc1 g2_wa_ok
    s_sleep 1
    s_branch g2_wa
g2_wa_ok:
g2_wa_done:
    s_barrier
    v_and_b32 v9, 31, v0
    s_and_b32 s24, s4, 1
    s_lshl_b32 s24, s24, 5
    s_add_u32 s24, s24, s44
    v_add_u32 v9, s24, v9
    v_lshlrev_b32 v9, 2, v9
    buffer_load_dword v8, v9, s[20:23], 0 offen sc1
    v_lshrrev_b32 v9, 3, v0
    v_lshlrev_b32 v9, 12, v9
    v_and_b32 v12, 7, v0
    v_lshlrev_b32 v12, 4, v12
    v_add_u32 v9, v9, v12
    s_lshl_b32 s24, s4, 4
    s_add_u32 s24, s24, s45
    s_lshl_b32 s24, s24, 12
    s_lshl_b32 s25, s44, 1
    s_add_u32 s25, s25, s24
    s_add_u32 m0, s98, 65536
    s_add_u32 s24, s25, 0
    buffer_load_dwordx4 v9, s[8:11], s24 offen sc1 lds
    s_add_u32 m0, s98, 66560
    s_add_u32 s24, s25, 32768
    buffer_load_dwordx4 v9, s[8:11], s24 offen sc1 lds
    ds_read_b128 v[32:35], v5 offset:0
    ds_read_b64_tr_b16 v[24:25], v6 offset:32768
    v_mfma_f32_32x32x16_bf16 v[64:79], v[40:43], v[48:51], v[64:79]
    ds_read_b64_tr_b16 v[26:27], v6 offset:33280
    ds_read_b128 v[36:39], v5 offset:4096
    v_mfma_f32_32x32x16_bf16 v[80:95], v[40:43], v[52:55], v[80:95]
    ds_read_b64_tr_b16 v[28:29], v7 offset:32768
    ds_read_b64_tr_b16 v[30:31], v7 offset:33280
    v_mfma_f32_32x32x16_bf16 v[96:111], v[44:47], v[48:51], v[96:111]
    v_mfma_f32_32x32x16_bf16 v[112:127], v[44:47], v[52:55], v[112:127]
    s_waitcnt lgkmcnt(0)
    s_waitcnt vmcnt(3)
    s_barrier
    ds_read_b128 v[48:51], v5 offset:8192
    ds_read_b64_tr_b16 v[40:41], v6 offset:40960
    v_mfma_f32_32x32x16_bf16 v[64:79], v[24:27], v[32:35], v[64:79]
    ds_read_b64_tr_b16 v[42:43], v6 offset:41472
    ds_read_b128 v[52:55], v5 offset:12288
    v_mfma_f32_32x32x16_bf16 v[80:95], v[24:27], v[36:39], v[80:95]
    ds_read_b64_tr_b16 v[44:45], v7 offset:40960
    ds_read_b64_tr_b16 v[46:47], v7 offset:41472
    v_mfma_f32_32x32x16_bf16 v[96:111], v[28:31], v[32:35], v[96:111]
    v_mfma_f32_32x32x16_bf16 v[112:127], v[28:31], v[36:39], v[112:127]
    s_waitcnt lgkmcnt(0)
    s_waitcnt vmcnt(0)
    s_barrier
    ds_read_b64_tr_b16 v[144:145], v60 offset:0
    ds_read_b64_tr_b16 v[146:147], v60 offset:512
    ds_read_b64_tr_b16 v[148:149], v60 offset:2048
    ds_read_b64_tr_b16 v[150:151], v60 offset:2560
    v_mfma_f32_32x32x16_bf16 v[64:79], v[40:43], v[48:51], v[64:79]
    v_mfma_f32_32x32x16_bf16 v[80:95], v[40:43], v[52:55], v[80:95]
    v_mfma_f32_32x32x16_bf16 v[96:111], v[44:47], v[48:51], v[96:111]
    v_mfma_f32_32x32x16_bf16 v[112:127], v[44:47], v[52:55], v[112:127]
    s_mov_b32 s39, 0xffff0000
    s_waitcnt lgkmcnt(0)
    v_sub_f32 v152, 1.0, v8
    v_lshlrev_b32 v128, 16, v144
    v_and_b32 v129, s39, v144
    v_lshlrev_b32 v130, 16, v145
    v_and_b32 v131, s39, v145
    v_lshlrev_b32 v132, 16, v146
    v_and_b32 v133, s39, v146
    v_lshlrev_b32 v134, 16, v147
    v_and_b32 v135, s39, v147
    v_lshlrev_b32 v136, 16, v148
    v_and_b32 v137, s39, v148
    v_lshlrev_b32 v138, 16, v149
    v_and_b32 v139, s39, v149
    v_lshlrev_b32 v140, 16, v150
    v_and_b32 v141, s39, v150
    v_lshlrev_b32 v142, 16, v151
    v_and_b32 v143, s39, v151
    v_mul_f32 v128, v8, v128
    v_mul_f32 v129, v8, v129
    v_mul_f32 v130, v8, v130
    v_mul_f32 v131, v8, v131
    v_mul_f32 v132, v8, v132
    v_mul_f32 v133, v8, v133
    v_mul_f32 v134, v8, v134
    v_mul_f32 v135, v8, v135
    v_mul_f32 v136, v8, v136
    v_mul_f32 v137, v8, v137
    v_mul_f32 v138, v8, v138
    v_mul_f32 v139, v8, v139
    v_mul_f32 v140, v8, v140
    v_mul_f32 v141, v8, v141
    v_mul_f32 v142, v8, v142
    v_mul_f32 v143, v8, v143
    s_cmp_eq_u32 s4, 0
    s_cbranch_scc1 g2_skipw0
    ds_write_b128 v56, v[64:67] offset:0
    ds_write_b128 v56, v[68:71] offset:1024
    ds_write_b128 v56, v[72:75] offset:2048
    ds_write_b128 v56, v[76:79] offset:3072
g2_skipw0:
    s_cmp_eq_u32 s4, 1
    s_cbranch_scc1 g2_skipw1
    ds_write_b128 v56, v[80:83] offset:16384
    ds_write_b128 v56, v[84:87] offset:17408
    ds_write_b128 v56, v[88:91] offset:18432
    ds_write_b128 v56, v[92:95] offset:19456
g2_skipw1:
    s_cmp_eq_u32 s4, 2
    s_cbranch_scc1 g2_skipw2
    ds_write_b128 v56, v[96:99] offset:32768
    ds_write_b128 v56, v[100:103] offset:33792
    ds_write_b128 v56, v[104:107] offset:34816
    ds_write_b128 v56, v[108:111] offset:35840
g2_skipw2:
    s_cmp_eq_u32 s4, 3
    s_cbranch_scc1 g2_skipw3
    ds_write_b128 v56, v[112:115] offset:49152
    ds_write_b128 v56, v[116:119] offset:50176
    ds_write_b128 v56, v[120:123] offset:51200
    ds_write_b128 v56, v[124:127] offset:52224
g2_skipw3:
    s_cmp_lg_u32 s4, 0
    s_cbranch_scc1 g2_skipm0
    v_fma_f32 v128, v152, v64, v128
    v_fma_f32 v129, v152, v65, v129
    v_fma_f32 v130, v152, v66, v130
    v_fma_f32 v131, v152, v67, v131
    v_fma_f32 v132, v152, v68, v132
    v_fma_f32 v133, v152, v69, v133
    v_fma_f32 v134, v152, v70, v134
    v_fma_f32 v135, v152, v71, v135
    v_fma_f32 v136, v152, v72, v136
    v_fma_f32 v137, v152, v73, v137
    v_fma_f32 v138, v152, v74, v138
    v_fma_f32 v139, v152, v75, v139
    v_fma_f32 v140, v152, v76, v140
    v_fma_f32 v141, v152, v77, v141
    v_fma_f32 v142, v152, v78, v142
    v_fma_f32 v143, v152, v79, v143
g2_skipm0:
    s_cmp_lg_u32 s4, 1
    s_cbranch_scc1 g2_skipm1
    v_fma_f32 v128, v152, v80, v128
    v_fma_f32 v129, v152, v81, v129
    v_fma_f32 v130, v152, v82, v130
    v_fma_f32 v131, v152, v83, v131
    v_fma_f32 v132, v152, v84, v132
    v_fma_f32 v133, v152, v85, v133
    v_fma_f32 v134, v152, v86, v134
    v_fma_f32 v135, v152, v87, v135
    v_fma_f32 v136, v152, v88, v136
    v_fma_f32 v137, v152, v89, v137
    v_fma_f32 v138, v152, v90, v138
    v_fma_f32 v139, v152, v91, v139
    v_fma_f32 v140, v152, v92, v140
    v_fma_f32 v141, v152, v93, v141
    v_fma_f32 v142, v152, v94, v142
    v_fma_f32 v143, v152, v95, v143
g2_skipm1:
    s_cmp_lg_u32 s4, 2
    s_cbranch_scc1 g2_skipm2
    v_fma_f32 v128, v152, v96, v128
    v_fma_f32 v129, v152, v97, v129
    v_fma_f32 v130, v152, v98, v130
    v_fma_f32 v131, v152, v99, v131
    v_fma_f32 v132, v152, v100, v132
    v_fma_f32 v133, v152, v101, v133
    v_fma_f32 v134, v152, v102, v134
    v_fma_f32 v135, v152, v103, v135
    v_fma_f32 v136, v152, v104, v136
    v_fma_f32 v137, v152, v105, v137
    v_fma_f32 v138, v152, v106, v138
    v_fma_f32 v139, v152, v107, v139
    v_fma_f32 v140, v152, v108, v140
    v_fma_f32 v141, v152, v109, v141
    v_fma_f32 v142, v152, v110, v142
    v_fma_f32 v143, v152, v111, v143
g2_skipm2:
    s_cmp_lg_u32 s4, 3
    s_cbranch_scc1 g2_skipm3
    v_fma_f32 v128, v152, v112, v128
    v_fma_f32 v129, v152, v113, v129
    v_fma_f32 v130, v152, v114, v130
    v_fma_f32 v131, v152, v115, v131
    v_fma_f32 v132, v152, v116, v132
    v_fma_f32 v133, v152, v117, v133
    v_fma_f32 v134, v152, v118, v134
    v_fma_f32 v135, v152, v119, v135
    v_fma_f32 v136, v152, v120, v136
    v_fma_f32 v137, v152, v121, v137
    v_fma_f32 v138, v152, v122, v138
    v_fma_f32 v139, v152, v123, v139
    v_fma_f32 v140, v152, v124, v140
    v_fma_f32 v141, v152, v125, v141
    v_fma_f32 v142, v152, v126, v142
    v_fma_f32 v143, v152, v127, v143
g2_skipm3:
    s_waitcnt lgkmcnt(0)
    s_barrier
    ds_read_b128 v[160:163], v57 offset:0
    ds_read_b128 v[164:167], v57 offset:1024
    ds_read_b128 v[168:171], v57 offset:2048
    ds_read_b128 v[172:175], v57 offset:3072
    ds_read_b128 v[176:179], v58 offset:0
    ds_read_b128 v[180:183], v58 offset:1024
    ds_read_b128 v[184:187], v58 offset:2048
    ds_read_b128 v[188:191], v58 offset:3072
    ds_read_b128 v[192:195], v59 offset:0
    ds_read_b128 v[196:199], v59 offset:1024
    ds_read_b128 v[200:203], v59 offset:2048
    ds_read_b128 v[204:207], v59 offset:3072
    s_waitcnt lgkmcnt(8)
    v_fmac_f32 v128, v152, v160
    v_fmac_f32 v129, v152, v161
    v_fmac_f32 v130, v152, v162
    v_fmac_f32 v131, v152, v163
    v_fmac_f32 v132, v152, v164
    v_fmac_f32 v133, v152, v165
    v_fmac_f32 v134, v152, v166
    v_fmac_f32 v135, v152, v167
    v_fmac_f32 v136, v152, v168
    v_fmac_f32 v137, v152, v169
    v_fmac_f32 v138, v152, v170
    v_fmac_f32 v139, v152, v171
    v_fmac_f32 v140, v152, v172
    v_fmac_f32 v141, v152, v173
    v_fmac_f32 v142, v152, v174
    v_fmac_f32 v143, v152, v175
    s_waitcnt lgkmcnt(4)
    v_fmac_f32 v128, v152, v176
    v_fmac_f32 v129, v152, v177
    v_fmac_f32 v130, v152, v178
    v_fmac_f32 v131, v152, v179
    v_fmac_f32 v132, v152, v180
    v_fmac_f32 v133, v152, v181
    v_fmac_f32 v134, v152, v182
    v_fmac_f32 v135, v152, v183
    v_fmac_f32 v136, v152, v184
    v_fmac_f32 v137, v152, v185
    v_fmac_f32 v138, v152, v186
    v_fmac_f32 v139, v152, v187
    v_fmac_f32 v140, v152, v188
    v_fmac_f32 v141, v152, v189
    v_fmac_f32 v142, v152, v190
    v_fmac_f32 v143, v152, v191
    s_waitcnt lgkmcnt(0)
    v_fmac_f32 v128, v152, v192
    v_fmac_f32 v129, v152, v193
    v_fmac_f32 v130, v152, v194
    v_fmac_f32 v131, v152, v195
    v_fmac_f32 v132, v152, v196
    v_fmac_f32 v133, v152, v197
    v_fmac_f32 v134, v152, v198
    v_fmac_f32 v135, v152, v199
    v_fmac_f32 v136, v152, v200
    v_fmac_f32 v137, v152, v201
    v_fmac_f32 v138, v152, v202
    v_fmac_f32 v139, v152, v203
    v_fmac_f32 v140, v152, v204
    v_fmac_f32 v141, v152, v205
    v_fmac_f32 v142, v152, v206
    v_fmac_f32 v143, v152, v207
    v_cvt_pk_bf16_f32 v24, v128, v129
    v_cvt_pk_bf16_f32 v25, v130, v131
    v_cvt_pk_bf16_f32 v26, v132, v133
    v_cvt_pk_bf16_f32 v27, v134, v135
    v_cvt_pk_bf16_f32 v28, v136, v137
    v_cvt_pk_bf16_f32 v29, v138, v139
    v_cvt_pk_bf16_f32 v30, v140, v141
    v_cvt_pk_bf16_f32 v31, v142, v143
    s_barrier
    ds_write_b128 v61, v[24:27] offset:0
    ds_write_b128 v62, v[28:31] offset:0
    s_waitcnt lgkmcnt(0)
    s_barrier
    ds_read_b128 v[32:35], v63 offset:0
    ds_read_b128 v[36:39], v63 offset:1024
    s_waitcnt lgkmcnt(1)
    s_add_u32 s24, s32, 0
    buffer_store_dwordx4 v[32:35], v23, s[12:15], s24 offen
    s_waitcnt lgkmcnt(0)
    s_add_u32 s24, s32, 7168
    buffer_store_dwordx4 v[36:39], v23, s[12:15], s24 offen
    s_endpgm
f_early:
    s_waitcnt vmcnt(0)
    s_barrier
    s_cmp_lg_u32 s4, 0
    s_cbranch_scc1 fe_flagged
    s_cmp_eq_u32 s58, 0
    s_cbranch_scc1 fe_flagged
    v_mul_u32_u24 v10, 128, v0
    v_mov_b32 v11, s37
    s_mov_b64 exec, 0x3fff
    buffer_store_dword v11, v10, s[52:55], s57 offen sc1
    s_mov_b64 exec, -1
fe_flagged:
    s_endpgm
f_side:
    s_and_b32 s40, s2, 7
    s_lshr_b32 s41, s2, 3
    s_mul_i32 s3, s40, 28
    s_add_u32 s3, s3, s41
    s_load_dwordx8 s[28:35], s[0:1], 8
    s_load_dwordx8 s[36:43], s[0:1], 40
    s_load_dwordx2 s[44:45], s[0:1], 128
    s_load_dwordx2 s[46:47], s[0:1], 120
    s_load_dwordx2 s[54:55], s[0:1], 0
    s_and_b32 s6, s4, 1
    s_lshr_b32 s7, s4, 1
    s_lshl_b32 s5, s3, 1
    s_add_u32 s5, s5, s7
    s_lshl_b32 s24, s5, 9
    s_lshl_b32 s25, s6, 8
    s_add_u32 s24, s24, s25
    v_lshlrev_b32 v2, 2, v0
    v_lshrrev_b32 v5, 4, v0
    v_lshrrev_b32 v6, 3, v0
    v_mul_u32_u24 v6, 896, v6
    v_and_b32 v7, 7, v0
    v_xor_b32 v7, v7, v5
    v_lshlrev_b32 v7, 4, v7
    v_add_u32 v3, v6, v7
    v_xor_b32 v7, 64, v7
    v_add_u32 v4, v6, v7
    s_and_b32 s56, s2, 31
    s_lshr_b32 s57, s2, 5
    s_lshl_b32 s58, s56, 6
    s_lshl_b32 s59, s4, 4
    s_add_u32 s58, s58, s59
    s_mul_i32 s58, s58, 896
    s_lshl_b32 s59, s57, 7
    s_add_u32 s58, s58, s59
    s_waitcnt lgkmcnt(0)
    s_add_u32 s20, s44, 14876672
    s_addc_u32 s21, s45, 0
    s_mov_b32 s22, 114688
    s_mov_b32 s23, 0x20000
    v_mov_b32 v255, v2
    s_mov_b32 s92, s24
    s_lshl_b32 s25, s3, 2
    s_load_dword s52, s[40:41], s25
    s_load_dword s51, s[42:43], s25
    s_mov_b32 s12, s54
    s_mov_b32 s13, s55
    s_mov_b32 s14, 1835008
    s_mov_b32 s15, 0x20000
    s_lshl_b32 s59, s4, 11
    s_add_u32 s59, s59, 66560
    v_mov_b32 v251, v3
    v_mov_b32 v252, v4
    s_add_u32 s16, s44, 9175040
    s_addc_u32 s17, s45, 0
    s_mov_b32 s18, 1835008
    s_mov_b32 s19, 0x20000
    s_mul_i32 s48, s4, 14848
    s_lshl_b32 s49, s7, 13
    s_add_u32 s49, s49, 59392
    s_mul_i32 s50, s7, 16640
    v_and_b32 v3, 31, v0
    v_mul_u32_u24 v3, 272, v3
    v_lshrrev_b32 v4, 5, v0
    v_lshlrev_b32 v4, 4, v4
    v_add_u32 v3, v3, v4
    v_add_u32 v220, s48, v3
    v_lshrrev_b32 v3, 4, v0
    v_lshrrev_b32 v4, 2, v0
    v_and_b32 v4, 3, v4
    v_and_b32 v5, 3, v0
    v_lshrrev_b32 v7, 1, v3
    v_mul_u32_u24 v8, 4160, v4
    v_and_b32 v9, 1, v3
    v_lshlrev_b32 v9, 5, v9
    v_add_u32 v8, v8, v9
    v_and_b32 v9, 1, v5
    v_lshlrev_b32 v9, 4, v9
    v_add_u32 v8, v8, v9
    v_lshrrev_b32 v9, 1, v5
    v_lshlrev_b32 v9, 3, v9
    v_add_u32 v8, v8, v9
    v_lshlrev_b32 v9, 4, v7
    v_sub_u32 v8, v8, v9
    s_lshl_b32 s24, s6, 10
    s_add_u32 s24, s24, s50
    s_add_u32 s24, s24, 24
    v_add_u32 v238, s24, v8
    v_lshlrev_b32 v8, 3, v3
    v_add_u32 v8, v8, v4
    v_lshlrev_b32 v8, 7, v8
    v_and_b32 v9, 1, v5
    v_lshlrev_b32 v9, 3, v9
    v_add_u32 v8, v8, v9
    v_add_u32 v8, 66560, v8
    v_lshrrev_b32 v9, 1, v5
    s_lshl_b32 s24, s4, 1
    v_add_u32 v9, s24, v9
    v_and_b32 v1, 1, v3
    v_lshlrev_b32 v1, 2, v1
    v_lshrrev_b32 v4, 1, v4
    v_add_u32 v1, v1, v4
    v_xor_b32 v9, v9, v1
    v_lshlrev_b32 v1, 4, v9
    v_add_u32 v245, v8, v1
    v_xor_b32 v9, 2, v9
    v_lshlrev_b32 v1, 4, v9
    v_add_u32 v246, v8, v1
    v_add_u32 v246, 512, v246
    v_and_b32 v3, 15, v0
    v_lshrrev_b32 v4, 4, v0
    v_and_b32 v5, 7, v3
    v_xor_b32 v5, v5, v4
    v_lshlrev_b32 v7, 7, v3
    v_add_u32 v7, s59, v7
    v_lshlrev_b32 v8, 4, v5
    v_add_u32 v247, v7, v8
    v_xor_b32 v8, 64, v8
    v_add_u32 v248, v7, v8
    v_lshlrev_b32 v249, 4, v0
    v_add_u32 v249, s59, v249
    v_lshrrev_b32 v3, 3, v0
    v_and_b32 v4, 7, v0
    v_xor_b32 v4, v4, v3
    v_lshlrev_b32 v4, 4, v4
    v_lshlrev_b32 v3, 12, v3
    v_add_u32 v250, v3, v4
    v_and_b32 v7, 31, v0
    v_lshlrev_b32 v7, 2, v7
    v_lshrrev_b32 v8, 5, v0
    v_lshlrev_b32 v9, 9, v8
    v_add_u32 v9, v7, v9
    v_add_u32 v222, s48, v9
    v_and_b32 v3, 31, v0
    v_mul_u32_u24 v4, 80, v3
    v_lshlrev_b32 v5, 4, v8
    v_add_u32 v4, v4, v5
    s_mul_i32 s24, s6, 1280
    s_sub_u32 s24, s49, s24
    s_add_u32 s24, s24, 1280
    v_add_u32 v239, s24, v4
    s_mul_i32 s24, s7, 18432
    s_lshl_b32 s25, s6, 12
    v_lshlrev_b32 v4, 4, v0
    v_add_u32 v4, s24, v4
    v_add_u32 v240, s25, v4
    s_xor_b32 s25, s25, 4096
    v_add_u32 v241, s25, v4
    v_and_b32 v3, 31, v0
    v_lshrrev_b32 v8, 5, v0
    v_mul_u32_u24 v7, 80, v3
    v_lshlrev_b32 v5, 4, v8
    v_add_u32 v7, v7, v5
    s_mul_i32 s24, s6, 2560
    s_add_u32 s24, s24, s49
    s_add_u32 s24, s24, 2480
    v_add_u32 v242, s24, v7
    v_lshlrev_b32 v7, 6, v3
    v_add_u32 v7, v7, v5
    s_mul_i32 s56, s7, 18432
    s_lshl_b32 s24, s6, 11
    s_add_u32 s56, s56, s24
    s_add_u32 s56, s56, 8192
    v_add_u32 v243, s56, v7
    s_lshl_b32 s24, s6, 8
    v_add_u32 v3, s24, v0
    s_mov_b32 s53, 52429
    v_mul_u32_u24 v4, s53, v3
    v_lshrrev_b32 v4, 18, v4
    v_mul_u32_u24 v5, 5, v4
    v_sub_u32 v5, v3, v5
    v_subrev_u32 v4, 31, v4
    v_lshlrev_b32 v7, 6, v4
    v_lshlrev_b32 v8, 4, v5
    v_add_u32 v7, v7, v8
    v_cmp_gt_u32 vcc, 64, v4
    v_cmp_gt_u32 s[40:41], 4, v5
    s_and_b64 vcc, vcc, s[40:41]
    v_mov_b32 v8, 0x80000000
    s_nop 0
    v_cndmask_b32 v223, v8, v7, vcc
    v_add_u32 v3, 64, v3
    v_mul_u32_u24 v4, s53, v3
    v_lshrrev_b32 v4, 18, v4
    v_mul_u32_u24 v5, 5, v4
    v_sub_u32 v5, v3, v5
    v_subrev_u32 v4, 31, v4
    v_lshlrev_b32 v7, 6, v4
    v_lshlrev_b32 v8, 4, v5
    v_add_u32 v7, v7, v8
    v_cmp_gt_u32 vcc, 64, v4
    v_cmp_gt_u32 s[40:41], 4, v5
    s_and_b64 vcc, vcc, s[40:41]
    v_mov_b32 v8, 0x80000000
    s_nop 0
    v_cndmask_b32 v224, v8, v7, vcc
    v_add_u32 v3, 64, v3
    v_mul_u32_u24 v4, s53, v3
    v_lshrrev_b32 v4, 18, v4
    v_mul_u32_u24 v5, 5, v4
    v_sub_u32 v5, v3, v5
    v_subrev_u32 v4, 31, v4
    v_lshlrev_b32 v7, 6, v4
    v_lshlrev_b32 v8, 4, v5
    v_add_u32 v7, v7, v8
    v_cmp_gt_u32 vcc, 64, v4
    v_cmp_gt_u32 s[40:41], 4, v5
    s_and_b64 vcc, vcc, s[40:41]
    v_mov_b32 v8, 0x80000000
    s_nop 0
    v_cndmask_b32 v225, v8, v7, vcc
    v_add_u32 v3, 64, v3
    v_mul_u32_u24 v4, s53, v3
    v_lshrrev_b32 v4, 18, v4
    v_mul_u32_u24 v5, 5, v4
    v_sub_u32 v5, v3, v5
    v_subrev_u32 v4, 31, v4
    v_lshlrev_b32 v7, 6, v4
    v_lshlrev_b32 v8, 4, v5
    v_add_u32 v7, v7, v8
    v_cmp_gt_u32 vcc, 64, v4
    v_cmp_gt_u32 s[40:41], 4, v5
    s_and_b64 vcc, vcc, s[40:41]
    v_mov_b32 v8, 0x80000000
    s_nop 0
    v_cndmask_b32 v226, v8, v7, vcc
    s_mul_i32 s24, s7, 29696
    v_and_b32 v3, 31, v0
    v_lshlrev_b32 v3, 2, v3
    v_add_u32 v3, s24, v3
    v_cmp_gt_u32 vcc, 32, v0
    v_mov_b32 v4, 1024
    v_mov_b32 v5, 0
    v_cndmask_b32 v4, v4, v5, vcc
    v_add_u32 v227, v3, v4
    v_mov_b32 v4, 1024
    v_mov_b32 v5, 128
    v_cndmask_b32 v4, v4, v5, vcc
    v_add_u32 v228, v3, v4
    v_mov_b32 v4, 2048
    v_mov_b32 v5, 256
    v_cndmask_b32 v4, v4, v5, vcc
    v_add_u32 v229, v3, v4
    v_mov_b32 v4, 2176
    v_mov_b32 v5, 384
    v_cndmask_b32 v4, v4, v5, vcc
    v_add_u32 v230, v3, v4
    v_mov_b32 v4, 2176
    v_mov_b32 v5, 512
    v_cndmask_b32 v4, v4, v5, vcc
    v_add_u32 v231, v3, v4
    v_mov_b32 v4, 2176
    v_mov_b32 v5, 640
    v_cndmask_b32 v4, v4, v5, vcc
    v_add_u32 v232, v3, v4
    v_mov_b32 v4, 2304
    v_mov_b32 v5, 768
    v_cndmask_b32 v4, v4, v5, vcc
    v_add_u32 v233, v3, v4
    v_mov_b32 v4, 1028
    v_mov_b32 v5, 896
    v_cndmask_b32 v4, v4, v5, vcc
    v_add_u32 v234, v3, v4
    v_cmp_eq_u32 s[40:41], 32, v0
    v_mov_b32 v4, 1024
    v_mov_b32 v5, 892
    v_cndmask_b32 v4, v4, v5, vcc
    v_mov_b32 v5, 1020
    v_cndmask_b32 v4, v4, v5, s[40:41]
    v_add_u32 v235, v3, v4
    v_lshlrev_b32 v236, 2, v0
    v_add_u32 v236, s24, v236
    s_lshl_b32 s24, s6, 7
    v_add_u32 v244, s24, v0
    v_lshlrev_b32 v237, 4, v244
    s_add_u32 s24, s50, 64
    v_add_u32 v237, s24, v237
    s_mov_b32 s10, 229376
    s_mov_b32 s11, 0x20000
    s_mov_b32 s8, s28
    s_mov_b32 s9, s29
    buffer_load_dword v10, v255, s[8:11], s92 offen
    s_nop 0
    s_mov_b32 s8, s30
    s_mov_b32 s9, s31
    buffer_load_dword v11, v255, s[8:11], s92 offen
    s_nop 0
    s_mov_b32 s8, s32
    s_mov_b32 s9, s33
    buffer_load_dword v12, v255, s[8:11], s92 offen
    s_nop 0
    s_mov_b32 s8, s34
    s_mov_b32 s9, s35
    buffer_load_dword v13, v255, s[8:11], s92 offen
    s_nop 0
    s_mov_b32 s8, s36
    s_mov_b32 s9, s37
    buffer_load_dword v14, v255, s[8:11], s92 offen
    s_nop 0
    s_mov_b32 s8, s38
    s_mov_b32 s9, s39
    buffer_load_dword v15, v255, s[8:11], s92 offen
    s_nop 0
    s_waitcnt lgkmcnt(0)
    s_lshl_b32 s24, s52, 16
    s_and_b32 s25, s52, 0xffff0000
    s_cmp_eq_u32 s7, 0
    s_cselect_b32 s52, s24, s25
    s_lshl_b32 s24, s51, 16
    s_and_b32 s25, s51, 0xffff0000
    s_cmp_eq_u32 s7, 0
    s_cselect_b32 s51, s24, s25
    v_mov_b32 v6, s52
    v_mul_f32 v7, 0x3fb8aa3b, v6
    s_mov_b32 s53, 0x3fb8aa3b
    v_fma_f32 v8, v6, s53, -v7
    v_fmac_f32 v8, 0x32a57060, v6
    v_exp_f32 v7, v7
    v_mul_f32 v8, 0x3f317218, v8
    s_nop 0
    v_fmac_f32 v7, v7, v8
    v_cvt_pk_bf16_f32 v7, v7, v7
    v_lshlrev_b32 v6, 16, v7
    s_waitcnt vmcnt(0)
    s_add_u32 m0, s59, 0
    s_add_u32 s24, s58, 0
    buffer_load_dwordx4 v251, s[12:15], s24 offen lds
    s_add_u32 m0, s59, 1024
    s_add_u32 s24, s58, 7168
    buffer_load_dwordx4 v252, s[12:15], s24 offen lds
    s_mov_b32 s54, 0xffff0000
    v_lshlrev_b32 v24, 16, v10
    v_lshlrev_b32 v25, 16, v11
    v_lshlrev_b32 v26, 16, v12
    v_lshlrev_b32 v27, 16, v13
    v_lshlrev_b32 v28, 16, v14
    v_lshlrev_b32 v29, 16, v15
    v_mul_f32 v24, v6, v24
    v_mul_f32 v25, v6, v25
    v_mul_f32 v26, v6, v26
    v_mul_f32 v27, v6, v27
    v_mul_f32 v16, v28, v26
    v_fma_f32 v16, -v29, v27, v16
    v_mul_f32 v17, v28, v27
    v_fmac_f32 v17, v29, v26
    v_mul_f32 v20, 0x3fb8aa3b, v24
    v_mul_f32 v21, 0.15915494, v25
    v_mul_f32 v30, 0x45000000, v20
    v_max_f32 v30, 0, v30
    v_exp_f32 v30, v30
    v_max_f32 v31, |v16|, |v17|
    v_mul_f32 v9, v30, v31
    v_and_b32 v24, s54, v10
    v_and_b32 v25, s54, v11
    v_and_b32 v26, s54, v12
    v_and_b32 v27, s54, v13
    v_and_b32 v28, s54, v14
    v_and_b32 v29, s54, v15
    v_mul_f32 v24, v6, v24
    v_mul_f32 v25, v6, v25
    v_mul_f32 v26, v6, v26
    v_mul_f32 v27, v6, v27
    v_mul_f32 v18, v28, v26
    v_fma_f32 v18, -v29, v27, v18
    v_mul_f32 v19, v28, v27
    v_fmac_f32 v19, v29, v26
    v_mul_f32 v22, 0x3fb8aa3b, v24
    v_mul_f32 v23, 0.15915494, v25
    v_mul_f32 v30, 0x45000000, v22
    v_max_f32 v30, 0, v30
    v_exp_f32 v30, v30
    v_max_f32 v31, |v18|, |v19|
    v_mul_f32 v30, v30, v31
    v_max_f32 v9, v9, v30
    s_nop 1
    v_max_f32_dpp v9, v9, v9 row_shr:1 row_mask:0xf bank_mask:0xf
    s_nop 1
    v_max_f32_dpp v9, v9, v9 row_shr:2 row_mask:0xf bank_mask:0xf
    s_nop 1
    v_max_f32_dpp v9, v9, v9 row_shr:4 row_mask:0xf bank_mask:0xf
    s_nop 1
    v_max_f32_dpp v9, v9, v9 row_shr:8 row_mask:0xf bank_mask:0xf
    s_nop 1
    v_max_f32_dpp v9, v9, v9 row_bcast:15 row_mask:0xa bank_mask:0xf
    s_nop 1
    v_max_f32_dpp v9, v9, v9 row_bcast:31 row_mask:0xc bank_mask:0xf
    s_nop 1
    v_readlane_b32 s24, v9, 63
    s_nop 3
    s_lshr_b32 s24, s24, 23
    s_max_u32 s24, s24, 8
    s_min_u32 s24, s24, 254
    s_sub_u32 s26, 261, s24
    s_lshl_b32 s26, s26, 23
    s_sub_u32 s27, s24, 7
    s_lshl_b32 s27, s27, 23
    v_exp_f32 v40, v20
    v_fract_f32 v41, v21
    v_cos_f32 v42, v41
    v_sin_f32 v43, v41
    s_nop 0
    v_mul_f32 v24, v40, v42
    v_mul_f32 v25, v40, v43
    v_sub_f32 v26, 0, v25
    v_mul_f32 v40, 0x43800000, v20
    v_mul_f32 v41, 0x43800000, v21
    v_exp_f32 v40, v40
    v_fract_f32 v41, v41
    v_cos_f32 v42, v41
    v_sin_f32 v43, v41
    s_nop 0
    v_mul_f32 v33, v40, v42
    v_mul_f32 v34, v40, v43
    v_sub_f32 v35, 0, v34
    v_mul_f32 v40, 0x41000000, v20
    v_mul_f32 v41, 0x41000000, v21
    v_exp_f32 v40, v40
    v_fract_f32 v41, v41
    v_cos_f32 v42, v41
    v_sin_f32 v43, v41
    s_nop 0
    v_mul_f32 v36, v40, v42
    v_mul_f32 v37, v40, v43
    v_sub_f32 v38, 0, v37
    v_mul_f32 v27, v24, v24
    v_mul_f32 v28, v24, v25
    v_fmac_f32 v27, v25, v26
    v_fmac_f32 v28, v25, v24
    v_sub_f32 v29, 0, v28
    v_mul_f32 v30, v27, v27
    v_mul_f32 v31, v27, v28
    v_fmac_f32 v30, v28, v29
    v_fmac_f32 v31, v28, v27
    v_sub_f32 v32, 0, v31
    v_mul_f32 v48, s26, v16
    v_mul_f32 v49, s26, v17
    v_sub_f32 v49, 0, v49
    v_cvt_pk_f16_f32 v104, v48, v49
    v_mul_f32 v46, v48, v24
    v_mul_f32 v47, v48, v26
    v_fmac_f32 v46, v49, v25
    v_fmac_f32 v47, v49, v24
    v_cvt_pk_f16_f32 v105, v46, v47
    v_mul_f32 v44, v46, v24
    v_mul_f32 v45, v46, v26
    v_fmac_f32 v44, v47, v25
    v_fmac_f32 v45, v47, v24
    v_cvt_pk_f16_f32 v106, v44, v45
    v_mul_f32 v46, v44, v24
    v_mul_f32 v47, v44, v26
    v_fmac_f32 v46, v45, v25
    v_fmac_f32 v47, v45, v24
    v_cvt_pk_f16_f32 v107, v46, v47
    v_mul_f32 v44, v46, v24
    v_mul_f32 v45, v46, v26
    v_fmac_f32 v44, v47, v25
    v_fmac_f32 v45, v47, v24
    v_cvt_pk_f16_f32 v108, v44, v45
    v_mul_f32 v46, v44, v24
    v_mul_f32 v47, v44, v26
    v_fmac_f32 v46, v45, v25
    v_fmac_f32 v47, v45, v24
    v_cvt_pk_f16_f32 v109, v46, v47
    v_mul_f32 v44, v46, v24
    v_mul_f32 v45, v46, v26
    v_fmac_f32 v44, v47, v25
    v_fmac_f32 v45, v47, v24
    v_cvt_pk_f16_f32 v110, v44, v45
    v_mul_f32 v46, v44, v24
    v_mul_f32 v47, v44, v26
    v_fmac_f32 v46, v45, v25
    v_fmac_f32 v47, v45, v24
    v_cvt_pk_f16_f32 v111, v46, v47
    v_mul_f32 v50, v48, v33
    v_mul_f32 v51, v48, v35
    v_fmac_f32 v50, v49, v34
    v_fmac_f32 v51, v49, v33
    v_cvt_pk_f16_f32 v112, v50, v51
    v_mul_f32 v44, v50, v27
    v_mul_f32 v45, v50, v29
    v_fmac_f32 v44, v51, v28
    v_fmac_f32 v45, v51, v27
    v_cvt_pk_f16_f32 v120, v44, v45
    v_mul_f32 v46, v44, v27
    v_mul_f32 v47, v44, v29
    v_fmac_f32 v46, v45, v28
    v_fmac_f32 v47, v45, v27
    v_cvt_pk_f16_f32 v121, v46, v47
    v_mul_f32 v44, v46, v27
    v_mul_f32 v45, v46, v29
    v_fmac_f32 v44, v47, v28
    v_fmac_f32 v45, v47, v27
    v_cvt_pk_f16_f32 v122, v44, v45
    v_mul_f32 v48, v50, v33
    v_mul_f32 v49, v50, v35
    v_fmac_f32 v48, v51, v34
    v_fmac_f32 v49, v51, v33
    v_cvt_pk_f16_f32 v113, v48, v49
    v_mul_f32 v44, v48, v30
    v_mul_f32 v45, v48, v32
    v_fmac_f32 v44, v49, v31
    v_fmac_f32 v45, v49, v30
    v_cvt_pk_f16_f32 v123, v44, v45
    v_mul_f32 v50, v48, v33
    v_mul_f32 v51, v48, v35
    v_fmac_f32 v50, v49, v34
    v_fmac_f32 v51, v49, v33
    v_cvt_pk_f16_f32 v114, v50, v51
    v_mul_f32 v44, v50, v30
    v_mul_f32 v45, v50, v32
    v_fmac_f32 v44, v51, v31
    v_fmac_f32 v45, v51, v30
    v_cvt_pk_f16_f32 v124, v44, v45
    v_mul_f32 v48, v50, v33
    v_mul_f32 v49, v50, v35
    v_fmac_f32 v48, v51, v34
    v_fmac_f32 v49, v51, v33
    v_cvt_pk_f16_f32 v115, v48, v49
    v_mul_f32 v50, v48, v33
    v_mul_f32 v51, v48, v35
    v_fmac_f32 v50, v49, v34
    v_fmac_f32 v51, v49, v33
    v_cvt_pk_f16_f32 v116, v50, v51
    v_mul_f32 v48, v50, v33
    v_mul_f32 v49, v50, v35
    v_fmac_f32 v48, v51, v34
    v_fmac_f32 v49, v51, v33
    v_cvt_pk_f16_f32 v117, v48, v49
    v_mul_f32 v50, v48, v33
    v_mul_f32 v51, v48, v35
    v_fmac_f32 v50, v49, v34
    v_fmac_f32 v51, v49, v33
    v_cvt_pk_f16_f32 v118, v50, v51
    v_mul_f32 v48, v50, v33
    v_mul_f32 v49, v50, v35
    v_fmac_f32 v48, v51, v34
    v_fmac_f32 v49, v51, v33
    v_cvt_pk_f16_f32 v119, v48, v49
    v_mov_b32 v125, 0x3c00
    v_cvt_pk_f16_f32 v126, v36, v37
    v_mul_f32 v44, v36, v36
    v_mul_f32 v45, v36, v37
    v_fmac_f32 v44, v37, v38
    v_fmac_f32 v45, v37, v36
    v_cvt_pk_f16_f32 v127, v44, v45
    v_mul_f32 v46, v44, v36
    v_mul_f32 v47, v44, v37
    v_fmac_f32 v46, v45, v38
    v_fmac_f32 v47, v45, v36
    v_cvt_pk_f16_f32 v128, v46, v47
    v_mul_f32 v44, v46, v36
    v_mul_f32 v45, v46, v37
    v_fmac_f32 v44, v47, v38
    v_fmac_f32 v45, v47, v36
    v_cvt_pk_f16_f32 v129, v44, v45
    v_mul_f32 v46, v44, v36
    v_mul_f32 v47, v44, v37
    v_fmac_f32 v46, v45, v38
    v_fmac_f32 v47, v45, v36
    v_cvt_pk_f16_f32 v130, v46, v47
    v_mul_f32 v44, v46, v36
    v_mul_f32 v45, v46, v37
    v_fmac_f32 v44, v47, v38
    v_fmac_f32 v45, v47, v36
    v_cvt_pk_f16_f32 v131, v44, v45
    v_mul_f32 v46, v44, v36
    v_mul_f32 v47, v44, v37
    v_fmac_f32 v46, v45, v38
    v_fmac_f32 v47, v45, v36
    v_cvt_pk_f16_f32 v132, v46, v47
    v_mul_f32 v44, v46, v36
    v_mul_f32 v45, v46, v37
    v_fmac_f32 v44, v47, v38
    v_fmac_f32 v45, v47, v36
    v_cvt_pk_f16_f32 v133, v44, v45
    v_mul_f32 v46, v44, v36
    v_mul_f32 v47, v44, v37
    v_fmac_f32 v46, v45, v38
    v_fmac_f32 v47, v45, v36
    v_cvt_pk_f16_f32 v134, v46, v47
    v_mul_f32 v44, v46, v36
    v_mul_f32 v45, v46, v37
    v_fmac_f32 v44, v47, v38
    v_fmac_f32 v45, v47, v36
    v_cvt_pk_f16_f32 v135, v44, v45
    v_mul_f32 v46, v44, v36
    v_mul_f32 v47, v44, v37
    v_fmac_f32 v46, v45, v38
    v_fmac_f32 v47, v45, v36
    v_cvt_pk_f16_f32 v136, v46, v47
    v_mul_f32 v44, v46, v36
    v_mul_f32 v45, v46, v37
    v_fmac_f32 v44, v47, v38
    v_fmac_f32 v45, v47, v36
    v_cvt_pk_f16_f32 v137, v44, v45
    v_mul_f32 v46, v44, v36
    v_mul_f32 v47, v44, v37
    v_fmac_f32 v46, v45, v38
    v_fmac_f32 v47, v45, v36
    v_cvt_pk_f16_f32 v138, v46, v47
    v_mul_f32 v44, v46, v36
    v_mul_f32 v45, v46, v37
    v_fmac_f32 v44, v47, v38
    v_fmac_f32 v45, v47, v36
    v_cvt_pk_f16_f32 v139, v44, v45
    v_mul_f32 v46, v44, v36
    v_mul_f32 v47, v44, v37
    v_fmac_f32 v46, v45, v38
    v_fmac_f32 v47, v45, v36
    v_cvt_pk_f16_f32 v140, v46, v47
    v_mul_f32 v44, v46, v36
    v_mul_f32 v45, v46, v37
    v_fmac_f32 v44, v47, v38
    v_fmac_f32 v45, v47, v36
    v_cvt_pk_f16_f32 v141, v44, v45
    v_mul_f32 v46, v44, v36
    v_mul_f32 v47, v44, v37
    v_fmac_f32 v46, v45, v38
    v_fmac_f32 v47, v45, v36
    v_cvt_pk_f16_f32 v142, v46, v47
    v_mul_f32 v44, v46, v36
    v_mul_f32 v45, v46, v37
    v_fmac_f32 v44, v47, v38
    v_fmac_f32 v45, v47, v36
    v_cvt_pk_f16_f32 v143, v44, v45
    v_mul_f32 v46, v44, v36
    v_mul_f32 v47, v44, v37
    v_fmac_f32 v46, v45, v38
    v_fmac_f32 v47, v45, v36
    v_cvt_pk_f16_f32 v144, v46, v47
    v_mul_f32 v44, v46, v36
    v_mul_f32 v45, v46, v37
    v_fmac_f32 v44, v47, v38
    v_fmac_f32 v45, v47, v36
    v_cvt_pk_f16_f32 v145, v44, v45
    v_mul_f32 v46, v44, v36
    v_mul_f32 v47, v44, v37
    v_fmac_f32 v46, v45, v38
    v_fmac_f32 v47, v45, v36
    v_cvt_pk_f16_f32 v146, v46, v47
    v_mul_f32 v44, v46, v36
    v_mul_f32 v45, v46, v37
    v_fmac_f32 v44, v47, v38
    v_fmac_f32 v45, v47, v36
    v_cvt_pk_f16_f32 v147, v44, v45
    v_mul_f32 v46, v44, v36
    v_mul_f32 v47, v44, v37
    v_fmac_f32 v46, v45, v38
    v_fmac_f32 v47, v45, v36
    v_cvt_pk_f16_f32 v148, v46, v47
    v_mul_f32 v44, v46, v36
    v_mul_f32 v45, v46, v37
    v_fmac_f32 v44, v47, v38
    v_fmac_f32 v45, v47, v36
    v_cvt_pk_f16_f32 v149, v44, v45
    v_mul_f32 v46, v44, v36
    v_mul_f32 v47, v44, v37
    v_fmac_f32 v46, v45, v38
    v_fmac_f32 v47, v45, v36
    v_cvt_pk_f16_f32 v150, v46, v47
    v_mul_f32 v44, v46, v36
    v_mul_f32 v45, v46, v37
    v_fmac_f32 v44, v47, v38
    v_fmac_f32 v45, v47, v36
    v_cvt_pk_f16_f32 v151, v44, v45
    v_mul_f32 v46, v44, v36
    v_mul_f32 v47, v44, v37
    v_fmac_f32 v46, v45, v38
    v_fmac_f32 v47, v45, v36
    v_cvt_pk_f16_f32 v152, v46, v47
    v_mul_f32 v44, v46, v36
    v_mul_f32 v45, v46, v37
    v_fmac_f32 v44, v47, v38
    v_fmac_f32 v45, v47, v36
    v_cvt_pk_f16_f32 v153, v44, v45
    v_mul_f32 v46, v44, v36
    v_mul_f32 v47, v44, v37
    v_fmac_f32 v46, v45, v38
    v_fmac_f32 v47, v45, v36
    v_cvt_pk_f16_f32 v154, v46, v47
    v_mul_f32 v44, v46, v36
    v_mul_f32 v45, v46, v37
    v_fmac_f32 v44, v47, v38
    v_fmac_f32 v45, v47, v36
    v_cvt_pk_f16_f32 v155, v44, v45
    v_mul_f32 v46, v44, v36
    v_mul_f32 v47, v44, v37
    v_fmac_f32 v46, v45, v38
    v_fmac_f32 v47, v45, v36
    v_cvt_pk_f16_f32 v156, v46, v47
    s_waitcnt vmcnt(0)
    s_barrier
    ds_read_b64_tr_b16 v[56:57], v245 offset:0
    ds_read_b64_tr_b16 v[58:59], v246 offset:0
    ds_read_b64_tr_b16 v[60:61], v245 offset:4096
    ds_read_b64_tr_b16 v[62:63], v246 offset:4096
    s_add_u32 s12, s44, 7340032
    s_addc_u32 s13, s45, 0
    s_mov_b32 s14, 1835008
    s_mov_b32 s15, 0x20000
    s_waitcnt lgkmcnt(0)
    s_barrier
    ds_write_b128 v247, v[56:59]
    ds_write_b128 v248, v[60:63]
    s_lshr_b32 s57, s2, 5
    s_lshl_b32 s57, s57, 6
    s_lshl_b32 s58, s4, 4
    s_add_u32 s57, s57, s58
    s_lshl_b32 s57, s57, 12
    s_and_b32 s58, s2, 31
    s_lshl_b32 s58, s58, 7
    s_add_u32 s57, s57, s58
    s_waitcnt lgkmcnt(0)
    ds_read_b128 v[56:59], v249
    ds_read_b128 v[60:63], v249 offset:1024
    s_waitcnt lgkmcnt(1)
    buffer_store_dwordx4 v[56:59], v250, s[12:15], s57 offen sc1
    s_add_u32 s57, s57, 32768
    s_waitcnt lgkmcnt(0)
    buffer_store_dwordx4 v[60:63], v250, s[12:15], s57 offen sc1
    s_mov_b32 m0, s48
    s_nop 0
    ds_write_addtid_b32 v104 offset:0
    ds_write_addtid_b32 v105 offset:272
    ds_write_addtid_b32 v106 offset:544
    ds_write_addtid_b32 v107 offset:816
    ds_write_addtid_b32 v108 offset:1088
    ds_write_addtid_b32 v109 offset:1360
    ds_write_addtid_b32 v110 offset:1632
    ds_write_addtid_b32 v111 offset:1904
    ds_write_addtid_b32 v112 offset:2176
    ds_write_addtid_b32 v113 offset:2448
    ds_write_addtid_b32 v114 offset:2720
    ds_write_addtid_b32 v115 offset:2992
    ds_write_addtid_b32 v116 offset:3264
    ds_write_addtid_b32 v117 offset:3536
    ds_write_addtid_b32 v118 offset:3808
    ds_write_addtid_b32 v119 offset:4080
    ds_write_addtid_b32 v120 offset:4352
    ds_write_addtid_b32 v121 offset:4624
    ds_write_addtid_b32 v122 offset:4896
    ds_write_addtid_b32 v123 offset:5168
    ds_write_addtid_b32 v124 offset:5440
    ds_write_addtid_b32 v125 offset:5712
    ds_write_addtid_b32 v126 offset:5984
    ds_write_addtid_b32 v127 offset:6256
    ds_write_addtid_b32 v128 offset:6528
    ds_write_addtid_b32 v129 offset:6800
    ds_write_addtid_b32 v130 offset:7072
    ds_write_addtid_b32 v131 offset:7344
    ds_write_addtid_b32 v132 offset:7616
    ds_write_addtid_b32 v133 offset:7888
    ds_write_addtid_b32 v134 offset:8160
    ds_write_addtid_b32 v135 offset:8432
    ds_write_addtid_b32 v136 offset:8704
    ds_write_addtid_b32 v137 offset:8976
    ds_write_addtid_b32 v138 offset:9248
    ds_write_addtid_b32 v139 offset:9520
    ds_write_addtid_b32 v140 offset:9792
    ds_write_addtid_b32 v141 offset:10064
    ds_write_addtid_b32 v142 offset:10336
    ds_write_addtid_b32 v143 offset:10608
    ds_write_addtid_b32 v144 offset:10880
    ds_write_addtid_b32 v145 offset:11152
    ds_write_addtid_b32 v146 offset:11424
    ds_write_addtid_b32 v147 offset:11696
    ds_write_addtid_b32 v148 offset:11968
    ds_write_addtid_b32 v149 offset:12240
    ds_write_addtid_b32 v150 offset:12512
    ds_write_addtid_b32 v151 offset:12784
    ds_write_addtid_b32 v152 offset:13056
    ds_write_addtid_b32 v153 offset:13328
    ds_write_addtid_b32 v154 offset:13600
    ds_write_addtid_b32 v155 offset:13872
    ds_write_addtid_b32 v156 offset:14144
    ds_read_b128 v[24:27], v220 offset:0
    ds_read_b128 v[56:59], v220 offset:5712
    ds_read_b128 v[28:31], v220 offset:32
    ds_read_b128 v[60:63], v220 offset:5744
    ds_read_b128 v[32:35], v220 offset:64
    ds_read_b128 v[64:67], v220 offset:5776
    ds_read_b128 v[36:39], v220 offset:96
    ds_read_b128 v[68:71], v220 offset:5808
    ds_read_b128 v[40:43], v220 offset:128
    ds_read_b128 v[72:75], v220 offset:5840
    ds_read_b128 v[44:47], v220 offset:160
    ds_read_b128 v[76:79], v220 offset:5872
    ds_read_b128 v[48:51], v220 offset:192
    ds_read_b128 v[80:83], v220 offset:5904
    ds_read_b128 v[52:55], v220 offset:224
    ds_read_b128 v[84:87], v220 offset:5936
    s_waitcnt lgkmcnt(14)
    v_mfma_f32_32x32x16_f16 v[88:103], v[24:27], v[56:59], 0
    s_waitcnt lgkmcnt(12)
    v_mfma_f32_32x32x16_f16 v[88:103], v[28:31], v[60:63], v[88:103]
    s_waitcnt lgkmcnt(10)
    v_mfma_f32_32x32x16_f16 v[88:103], v[32:35], v[64:67], v[88:103]
    s_waitcnt lgkmcnt(8)
    v_mfma_f32_32x32x16_f16 v[88:103], v[36:39], v[68:71], v[88:103]
    s_waitcnt lgkmcnt(6)
    v_mfma_f32_32x32x16_f16 v[88:103], v[40:43], v[72:75], v[88:103]
    s_waitcnt lgkmcnt(4)
    v_mfma_f32_32x32x16_f16 v[88:103], v[44:47], v[76:79], v[88:103]
    s_waitcnt lgkmcnt(2)
    v_mfma_f32_32x32x16_f16 v[88:103], v[48:51], v[80:83], v[88:103]
    s_waitcnt lgkmcnt(0)
    v_mfma_f32_32x32x16_f16 v[88:103], v[52:55], v[84:87], v[88:103]
    v_exp_f32 v40, v22
    v_fract_f32 v41, v23
    v_cos_f32 v42, v41
    v_sin_f32 v43, v41
    s_nop 0
    v_mul_f32 v24, v40, v42
    v_mul_f32 v25, v40, v43
    v_sub_f32 v26, 0, v25
    v_mul_f32 v40, 0x43800000, v22
    v_mul_f32 v41, 0x43800000, v23
    v_exp_f32 v40, v40
    v_fract_f32 v41, v41
    v_cos_f32 v42, v41
    v_sin_f32 v43, v41
    s_nop 0
    v_mul_f32 v33, v40, v42
    v_mul_f32 v34, v40, v43
    v_sub_f32 v35, 0, v34
    v_mul_f32 v40, 0x41000000, v22
    v_mul_f32 v41, 0x41000000, v23
    v_exp_f32 v40, v40
    v_fract_f32 v41, v41
    v_cos_f32 v42, v41
    v_sin_f32 v43, v41
    s_nop 0
    v_mul_f32 v36, v40, v42
    v_mul_f32 v37, v40, v43
    v_sub_f32 v38, 0, v37
    v_mul_f32 v27, v24, v24
    v_mul_f32 v28, v24, v25
    v_fmac_f32 v27, v25, v26
    v_fmac_f32 v28, v25, v24
    v_sub_f32 v29, 0, v28
    v_mul_f32 v30, v27, v27
    v_mul_f32 v31, v27, v28
    v_fmac_f32 v30, v28, v29
    v_fmac_f32 v31, v28, v27
    v_sub_f32 v32, 0, v31
    v_mul_f32 v48, s26, v18
    v_mul_f32 v49, s26, v19
    v_sub_f32 v49, 0, v49
    v_cvt_pk_f16_f32 v160, v48, v49
    v_mul_f32 v46, v48, v24
    v_mul_f32 v47, v48, v26
    v_fmac_f32 v46, v49, v25
    v_fmac_f32 v47, v49, v24
    v_cvt_pk_f16_f32 v161, v46, v47
    v_mul_f32 v44, v46, v24
    v_mul_f32 v45, v46, v26
    v_fmac_f32 v44, v47, v25
    v_fmac_f32 v45, v47, v24
    v_cvt_pk_f16_f32 v162, v44, v45
    v_mul_f32 v46, v44, v24
    v_mul_f32 v47, v44, v26
    v_fmac_f32 v46, v45, v25
    v_fmac_f32 v47, v45, v24
    v_cvt_pk_f16_f32 v163, v46, v47
    v_mul_f32 v44, v46, v24
    v_mul_f32 v45, v46, v26
    v_fmac_f32 v44, v47, v25
    v_fmac_f32 v45, v47, v24
    v_cvt_pk_f16_f32 v164, v44, v45
    v_mul_f32 v46, v44, v24
    v_mul_f32 v47, v44, v26
    v_fmac_f32 v46, v45, v25
    v_fmac_f32 v47, v45, v24
    v_cvt_pk_f16_f32 v165, v46, v47
    v_mul_f32 v44, v46, v24
    v_mul_f32 v45, v46, v26
    v_fmac_f32 v44, v47, v25
    v_fmac_f32 v45, v47, v24
    v_cvt_pk_f16_f32 v166, v44, v45
    v_mul_f32 v46, v44, v24
    v_mul_f32 v47, v44, v26
    v_fmac_f32 v46, v45, v25
    v_fmac_f32 v47, v45, v24
    v_cvt_pk_f16_f32 v167, v46, v47
    v_mul_f32 v50, v48, v33
    v_mul_f32 v51, v48, v35
    v_fmac_f32 v50, v49, v34
    v_fmac_f32 v51, v49, v33
    v_cvt_pk_f16_f32 v168, v50, v51
    v_mul_f32 v44, v50, v27
    v_mul_f32 v45, v50, v29
    v_fmac_f32 v44, v51, v28
    v_fmac_f32 v45, v51, v27
    v_cvt_pk_f16_f32 v176, v44, v45
    v_mul_f32 v46, v44, v27
    v_mul_f32 v47, v44, v29
    v_fmac_f32 v46, v45, v28
    v_fmac_f32 v47, v45, v27
    v_cvt_pk_f16_f32 v177, v46, v47
    v_mul_f32 v44, v46, v27
    v_mul_f32 v45, v46, v29
    v_fmac_f32 v44, v47, v28
    v_fmac_f32 v45, v47, v27
    v_cvt_pk_f16_f32 v178, v44, v45
    v_mul_f32 v48, v50, v33
    v_mul_f32 v49, v50, v35
    v_fmac_f32 v48, v51, v34
    v_fmac_f32 v49, v51, v33
    v_cvt_pk_f16_f32 v169, v48, v49
    v_mul_f32 v44, v48, v30
    v_mul_f32 v45, v48, v32
    v_fmac_f32 v44, v49, v31
    v_fmac_f32 v45, v49, v30
    v_cvt_pk_f16_f32 v179, v44, v45
    v_mul_f32 v50, v48, v33
    v_mul_f32 v51, v48, v35
    v_fmac_f32 v50, v49, v34
    v_fmac_f32 v51, v49, v33
    v_cvt_pk_f16_f32 v170, v50, v51
    v_mul_f32 v44, v50, v30
    v_mul_f32 v45, v50, v32
    v_fmac_f32 v44, v51, v31
    v_fmac_f32 v45, v51, v30
    v_cvt_pk_f16_f32 v180, v44, v45
    v_mul_f32 v48, v50, v33
    v_mul_f32 v49, v50, v35
    v_fmac_f32 v48, v51, v34
    v_fmac_f32 v49, v51, v33
    v_cvt_pk_f16_f32 v171, v48, v49
    v_mul_f32 v50, v48, v33
    v_mul_f32 v51, v48, v35
    v_fmac_f32 v50, v49, v34
    v_fmac_f32 v51, v49, v33
    v_cvt_pk_f16_f32 v172, v50, v51
    v_mul_f32 v48, v50, v33
    v_mul_f32 v49, v50, v35
    v_fmac_f32 v48, v51, v34
    v_fmac_f32 v49, v51, v33
    v_cvt_pk_f16_f32 v173, v48, v49
    v_mul_f32 v50, v48, v33
    v_mul_f32 v51, v48, v35
    v_fmac_f32 v50, v49, v34
    v_fmac_f32 v51, v49, v33
    v_cvt_pk_f16_f32 v174, v50, v51
    v_mul_f32 v48, v50, v33
    v_mul_f32 v49, v50, v35
    v_fmac_f32 v48, v51, v34
    v_fmac_f32 v49, v51, v33
    v_cvt_pk_f16_f32 v175, v48, v49
    s_waitcnt vmcnt(0)
    s_barrier
    s_cmp_lg_u32 s4, 0
    s_cbranch_scc1 side_uflagged
    v_mov_b32 v1, 0
    s_mov_b32 s57, 0
side_wr:
    global_load_dword v2, v1, s[46:47] sc1
    s_waitcnt vmcnt(0)
    v_readfirstlane_b32 s53, v2
    s_add_u32 s57, s57, 1
    s_cmp_ge_u32 s57, 400000
    s_cbranch_scc1 side_wr_ok
    s_cmp_lg_u32 s53, 0
    s_cbranch_scc1 side_wr_ok
    s_sleep 8
    s_branch side_wr
side_wr_ok:
    s_lshr_b32 s57, s2, 5
    s_lshl_b32 s57, s57, 5
    s_add_u32 s57, s57, 448
    s_lshl_b32 s57, s57, 7
    s_and_b32 s58, s2, 31
    s_lshl_b32 s58, s58, 2
    s_add_u32 s57, s57, s58
    v_mul_u32_u24 v1, 128, v0
    v_mov_b32 v2, s53
    s_mov_b64 exec, 0xffffffff
    buffer_store_dword v2, v1, s[20:23], s57 offen sc1
    s_mov_b64 exec, -1
side_uflagged:
    v_mov_b32 v181, 0x3c00
    v_cvt_pk_f16_f32 v182, v36, v37
    v_mul_f32 v44, v36, v36
    v_mul_f32 v45, v36, v37
    v_fmac_f32 v44, v37, v38
    v_fmac_f32 v45, v37, v36
    v_cvt_pk_f16_f32 v183, v44, v45
    v_mul_f32 v46, v44, v36
    v_mul_f32 v47, v44, v37
    v_fmac_f32 v46, v45, v38
    v_fmac_f32 v47, v45, v36
    v_cvt_pk_f16_f32 v184, v46, v47
    v_mul_f32 v44, v46, v36
    v_mul_f32 v45, v46, v37
    v_fmac_f32 v44, v47, v38
    v_fmac_f32 v45, v47, v36
    v_cvt_pk_f16_f32 v185, v44, v45
    v_mul_f32 v46, v44, v36
    v_mul_f32 v47, v44, v37
    v_fmac_f32 v46, v45, v38
    v_fmac_f32 v47, v45, v36
    v_cvt_pk_f16_f32 v186, v46, v47
    v_mul_f32 v44, v46, v36
    v_mul_f32 v45, v46, v37
    v_fmac_f32 v44, v47, v38
    v_fmac_f32 v45, v47, v36
    v_cvt_pk_f16_f32 v187, v44, v45
    v_mul_f32 v46, v44, v36
    v_mul_f32 v47, v44, v37
    v_fmac_f32 v46, v45, v38
    v_fmac_f32 v47, v45, v36
    v_cvt_pk_f16_f32 v188, v46, v47
    v_mul_f32 v44, v46, v36
    v_mul_f32 v45, v46, v37
    v_fmac_f32 v44, v47, v38
    v_fmac_f32 v45, v47, v36
    v_cvt_pk_f16_f32 v189, v44, v45
    v_mul_f32 v46, v44, v36
    v_mul_f32 v47, v44, v37
    v_fmac_f32 v46, v45, v38
    v_fmac_f32 v47, v45, v36
    v_cvt_pk_f16_f32 v190, v46, v47
    v_mul_f32 v44, v46, v36
    v_mul_f32 v45, v46, v37
    v_fmac_f32 v44, v47, v38
    v_fmac_f32 v45, v47, v36
    v_cvt_pk_f16_f32 v191, v44, v45
    v_mul_f32 v46, v44, v36
    v_mul_f32 v47, v44, v37
    v_fmac_f32 v46, v45, v38
    v_fmac_f32 v47, v45, v36
    v_cvt_pk_f16_f32 v192, v46, v47
    v_mul_f32 v44, v46, v36
    v_mul_f32 v45, v46, v37
    v_fmac_f32 v44, v47, v38
    v_fmac_f32 v45, v47, v36
    v_cvt_pk_f16_f32 v193, v44, v45
    v_mul_f32 v46, v44, v36
    v_mul_f32 v47, v44, v37
    v_fmac_f32 v46, v45, v38
    v_fmac_f32 v47, v45, v36
    v_cvt_pk_f16_f32 v194, v46, v47
    v_mul_f32 v44, v46, v36
    v_mul_f32 v45, v46, v37
    v_fmac_f32 v44, v47, v38
    v_fmac_f32 v45, v47, v36
    v_cvt_pk_f16_f32 v195, v44, v45
    v_mul_f32 v46, v44, v36
    v_mul_f32 v47, v44, v37
    v_fmac_f32 v46, v45, v38
    v_fmac_f32 v47, v45, v36
    v_cvt_pk_f16_f32 v196, v46, v47
    v_mul_f32 v44, v46, v36
    v_mul_f32 v45, v46, v37
    v_fmac_f32 v44, v47, v38
    v_fmac_f32 v45, v47, v36
    v_cvt_pk_f16_f32 v197, v44, v45
    v_mul_f32 v46, v44, v36
    v_mul_f32 v47, v44, v37
    v_fmac_f32 v46, v45, v38
    v_fmac_f32 v47, v45, v36
    v_cvt_pk_f16_f32 v198, v46, v47
    v_mul_f32 v44, v46, v36
    v_mul_f32 v45, v46, v37
    v_fmac_f32 v44, v47, v38
    v_fmac_f32 v45, v47, v36
    v_cvt_pk_f16_f32 v199, v44, v45
    v_mul_f32 v46, v44, v36
    v_mul_f32 v47, v44, v37
    v_fmac_f32 v46, v45, v38
    v_fmac_f32 v47, v45, v36
    v_cvt_pk_f16_f32 v200, v46, v47
    v_mul_f32 v44, v46, v36
    v_mul_f32 v45, v46, v37
    v_fmac_f32 v44, v47, v38
    v_fmac_f32 v45, v47, v36
    v_cvt_pk_f16_f32 v201, v44, v45
    v_mul_f32 v46, v44, v36
    v_mul_f32 v47, v44, v37
    v_fmac_f32 v46, v45, v38
    v_fmac_f32 v47, v45, v36
    v_cvt_pk_f16_f32 v202, v46, v47
    v_mul_f32 v44, v46, v36
    v_mul_f32 v45, v46, v37
    v_fmac_f32 v44, v47, v38
    v_fmac_f32 v45, v47, v36
    v_cvt_pk_f16_f32 v203, v44, v45
    v_mul_f32 v46, v44, v36
    v_mul_f32 v47, v44, v37
    v_fmac_f32 v46, v45, v38
    v_fmac_f32 v47, v45, v36
    v_cvt_pk_f16_f32 v204, v46, v47
    v_mul_f32 v44, v46, v36
    v_mul_f32 v45, v46, v37
    v_fmac_f32 v44, v47, v38
    v_fmac_f32 v45, v47, v36
    v_cvt_pk_f16_f32 v205, v44, v45
    v_mul_f32 v46, v44, v36
    v_mul_f32 v47, v44, v37
    v_fmac_f32 v46, v45, v38
    v_fmac_f32 v47, v45, v36
    v_cvt_pk_f16_f32 v206, v46, v47
    v_mul_f32 v44, v46, v36
    v_mul_f32 v45, v46, v37
    v_fmac_f32 v44, v47, v38
    v_fmac_f32 v45, v47, v36
    v_cvt_pk_f16_f32 v207, v44, v45
    v_mul_f32 v46, v44, v36
    v_mul_f32 v47, v44, v37
    v_fmac_f32 v46, v45, v38
    v_fmac_f32 v47, v45, v36
    v_cvt_pk_f16_f32 v208, v46, v47
    v_mul_f32 v44, v46, v36
    v_mul_f32 v45, v46, v37
    v_fmac_f32 v44, v47, v38
    v_fmac_f32 v45, v47, v36
    v_cvt_pk_f16_f32 v209, v44, v45
    v_mul_f32 v46, v44, v36
    v_mul_f32 v47, v44, v37
    v_fmac_f32 v46, v45, v38
    v_fmac_f32 v47, v45, v36
    v_cvt_pk_f16_f32 v210, v46, v47
    v_mul_f32 v44, v46, v36
    v_mul_f32 v45, v46, v37
    v_fmac_f32 v44, v47, v38
    v_fmac_f32 v45, v47, v36
    v_cvt_pk_f16_f32 v211, v44, v45
    v_mul_f32 v46, v44, v36
    v_mul_f32 v47, v44, v37
    v_fmac_f32 v46, v45, v38
    v_fmac_f32 v47, v45, v36
    v_cvt_pk_f16_f32 v212, v46, v47
    s_cmp_lg_u32 s4, 0
    s_cbranch_scc1 side_gated
    s_add_u32 s57, s3, 448
    s_lshl_b32 s57, s57, 7
    s_add_u32 s58, s2, 672
    s_lshl_b32 s58, s58, 7
    v_lshlrev_b32 v1, 2, v0
    v_add_u32 v1, s57, v1
    v_mov_b32 v2, s58
    v_cmp_eq_u32 vcc, 32, v0
    s_mov_b32 s58, 0
    s_nop 0
    v_cndmask_b32 v1, v1, v2, vcc
side_wc:
    buffer_load_dword v2, v1, s[20:23], 0 offen sc1
    s_waitcnt vmcnt(0)
    v_cmp_eq_u32 vcc, s53, v2
    s_add_u32 s58, s58, 1
    s_cmp_ge_u32 s58, 400000
    s_cbranch_scc1 side_gated
    s_and_b32 s24, vcc_hi, 1
    s_cmp_eq_u32 vcc_lo, -1
    s_cselect_b32 s24, s24, 0
    s_cmp_lg_u32 s24, 0
    s_cbranch_scc1 side_gated
    s_sleep 16
    s_branch side_wc
side_gated:
    s_barrier
    s_lshl_b32 s25, s5, 12
    s_lshl_b32 s55, s6, 12
    s_add_u32 s55, s55, s49
    s_add_u32 m0, s55, 0
    s_nop 0
    buffer_load_dwordx4 v223, s[12:15], s25 offen sc1 lds
    s_add_u32 m0, s55, 1024
    s_nop 0
    buffer_load_dwordx4 v224, s[12:15], s25 offen sc1 lds
    s_add_u32 m0, s55, 2048
    s_nop 0
    buffer_load_dwordx4 v225, s[12:15], s25 offen sc1 lds
    s_add_u32 m0, s55, 3072
    s_nop 0
    buffer_load_dwordx4 v226, s[12:15], s25 offen sc1 lds
    s_mov_b32 m0, s48
    s_nop 0
    ds_write_addtid_b32 v160 offset:0
    ds_write_addtid_b32 v161 offset:272
    ds_write_addtid_b32 v162 offset:544
    ds_write_addtid_b32 v163 offset:816
    ds_write_addtid_b32 v164 offset:1088
    ds_write_addtid_b32 v165 offset:1360
    ds_write_addtid_b32 v166 offset:1632
    ds_write_addtid_b32 v167 offset:1904
    ds_write_addtid_b32 v168 offset:2176
    ds_write_addtid_b32 v169 offset:2448
    ds_write_addtid_b32 v170 offset:2720
    ds_write_addtid_b32 v171 offset:2992
    ds_write_addtid_b32 v172 offset:3264
    ds_write_addtid_b32 v173 offset:3536
    ds_write_addtid_b32 v174 offset:3808
    ds_write_addtid_b32 v175 offset:4080
    ds_write_addtid_b32 v176 offset:4352
    ds_write_addtid_b32 v177 offset:4624
    ds_write_addtid_b32 v178 offset:4896
    ds_write_addtid_b32 v179 offset:5168
    ds_write_addtid_b32 v180 offset:5440
    ds_write_addtid_b32 v181 offset:5712
    ds_write_addtid_b32 v182 offset:5984
    ds_write_addtid_b32 v183 offset:6256
    ds_write_addtid_b32 v184 offset:6528
    ds_write_addtid_b32 v185 offset:6800
    ds_write_addtid_b32 v186 offset:7072
    ds_write_addtid_b32 v187 offset:7344
    ds_write_addtid_b32 v188 offset:7616
    ds_write_addtid_b32 v189 offset:7888
    ds_write_addtid_b32 v190 offset:8160
    ds_write_addtid_b32 v191 offset:8432
    ds_write_addtid_b32 v192 offset:8704
    ds_write_addtid_b32 v193 offset:8976
    ds_write_addtid_b32 v194 offset:9248
    ds_write_addtid_b32 v195 offset:9520
    ds_write_addtid_b32 v196 offset:9792
    ds_write_addtid_b32 v197 offset:10064
    ds_write_addtid_b32 v198 offset:10336
    ds_write_addtid_b32 v199 offset:10608
    ds_write_addtid_b32 v200 offset:10880
    ds_write_addtid_b32 v201 offset:11152
    ds_write_addtid_b32 v202 offset:11424
    ds_write_addtid_b32 v203 offset:11696
    ds_write_addtid_b32 v204 offset:11968
    ds_write_addtid_b32 v205 offset:12240
    ds_write_addtid_b32 v206 offset:12512
    ds_write_addtid_b32 v207 offset:12784
    ds_write_addtid_b32 v208 offset:13056
    ds_write_addtid_b32 v209 offset:13328
    ds_write_addtid_b32 v210 offset:13600
    ds_write_addtid_b32 v211 offset:13872
    ds_write_addtid_b32 v212 offset:14144
    ds_read_b128 v[104:107], v220 offset:0
    ds_read_b128 v[136:139], v220 offset:5712
    ds_read_b128 v[108:111], v220 offset:32
    ds_read_b128 v[140:143], v220 offset:5744
    ds_read_b128 v[112:115], v220 offset:64
    ds_read_b128 v[144:147], v220 offset:5776
    ds_read_b128 v[116:119], v220 offset:96
    ds_read_b128 v[148:151], v220 offset:5808
    ds_read_b128 v[120:123], v220 offset:128
    ds_read_b128 v[152:155], v220 offset:5840
    ds_read_b128 v[124:127], v220 offset:160
    ds_read_b128 v[156:159], v220 offset:5872
    ds_read_b128 v[128:131], v220 offset:192
    ds_read_b128 v[160:163], v220 offset:5904
    ds_read_b128 v[132:135], v220 offset:224
    ds_read_b128 v[164:167], v220 offset:5936
    s_waitcnt lgkmcnt(14)
    v_mfma_f32_32x32x16_f16 v[88:103], v[104:107], v[136:139], v[88:103]
    s_waitcnt lgkmcnt(12)
    v_mfma_f32_32x32x16_f16 v[88:103], v[108:111], v[140:143], v[88:103]
    s_waitcnt lgkmcnt(10)
    v_mfma_f32_32x32x16_f16 v[88:103], v[112:115], v[144:147], v[88:103]
    s_waitcnt lgkmcnt(8)
    v_mfma_f32_32x32x16_f16 v[88:103], v[116:119], v[148:151], v[88:103]
    s_waitcnt lgkmcnt(6)
    v_mfma_f32_32x32x16_f16 v[88:103], v[120:123], v[152:155], v[88:103]
    s_waitcnt lgkmcnt(4)
    v_mfma_f32_32x32x16_f16 v[88:103], v[124:127], v[156:159], v[88:103]
    s_waitcnt lgkmcnt(2)
    v_mfma_f32_32x32x16_f16 v[88:103], v[128:131], v[160:163], v[88:103]
    s_waitcnt lgkmcnt(0)
    v_mfma_f32_32x32x16_f16 v[88:103], v[132:135], v[164:167], v[88:103]
    s_nop 15
    s_nop 3
    v_mul_f32 v88, s27, v88
    ds_write_b32 v222, v88 offset:0
    v_mul_f32 v89, s27, v89
    ds_write_b32 v222, v89 offset:128
    v_mul_f32 v90, s27, v90
    ds_write_b32 v222, v90 offset:256
    v_mul_f32 v91, s27, v91
    ds_write_b32 v222, v91 offset:384
    v_mul_f32 v92, s27, v92
    ds_write_b32 v222, v92 offset:1024
    v_mul_f32 v93, s27, v93
    ds_write_b32 v222, v93 offset:1152
    v_mul_f32 v94, s27, v94
    ds_write_b32 v222, v94 offset:1280
    v_mul_f32 v95, s27, v95
    ds_write_b32 v222, v95 offset:1408
    v_mul_f32 v96, s27, v96
    ds_write_b32 v222, v96 offset:2048
    v_mul_f32 v97, s27, v97
    ds_write_b32 v222, v97 offset:2176
    v_mul_f32 v98, s27, v98
    ds_write_b32 v222, v98 offset:2304
    v_mul_f32 v99, s27, v99
    ds_write_b32 v222, v99 offset:2432
    s_waitcnt lgkmcnt(0)
    s_barrier
    s_cmp_eq_u32 s6, 0
    s_cbranch_scc0 side_exp_h1
    ds_read_b32 v24, v227
    ds_read_b32 v40, v227 offset:14848
    ds_read_b32 v25, v228
    ds_read_b32 v41, v228 offset:14848
    ds_read_b32 v26, v229
    ds_read_b32 v42, v229 offset:14848
    ds_read_b32 v27, v230
    ds_read_b32 v43, v230 offset:14848
    ds_read_b32 v28, v231
    ds_read_b32 v44, v231 offset:14848
    ds_read_b32 v29, v232
    ds_read_b32 v45, v232 offset:14848
    ds_read_b32 v30, v233
    ds_read_b32 v46, v233 offset:14848
    ds_read_b32 v31, v234
    ds_read_b32 v47, v234 offset:14848
    ds_read_b32 v32, v235
    ds_read_b32 v48, v235 offset:14848
    ds_read_b32 v33, v236 offset:1152
    ds_read_b32 v49, v236 offset:16000
    ds_read_b32 v34, v236 offset:2432
    ds_read_b32 v50, v236 offset:17280
    ds_read_b32 v35, v236 offset:1156
    ds_read_b32 v51, v236 offset:16004
    v_cmp_eq_u32 vcc, 0, v0
    v_mov_b32 v11, 0
    s_waitcnt lgkmcnt(0)
    v_add_f32 v24, v24, v40
    v_add_f32 v25, v25, v41
    v_add_f32 v26, v26, v42
    v_add_f32 v27, v27, v43
    v_add_f32 v28, v28, v44
    v_add_f32 v29, v29, v45
    v_add_f32 v30, v30, v46
    v_add_f32 v31, v31, v47
    v_add_f32 v32, v32, v48
    v_add_f32 v33, v33, v49
    v_add_f32 v34, v34, v50
    v_add_f32 v35, v35, v51
    v_cndmask_b32 v32, v32, v11, vcc
    v_cvt_pk_bf16_f32 v40, v24, v25
    v_cvt_pk_bf16_f32 v41, v26, v27
    v_cvt_pk_bf16_f32 v42, v28, v29
    v_cvt_pk_bf16_f32 v43, v30, v31
    v_cvt_pk_bf16_f32 v44, v32, v24
    v_cvt_pk_bf16_f32 v45, v25, v26
    v_cvt_pk_bf16_f32 v46, v27, v28
    v_cvt_pk_bf16_f32 v47, v29, v30
    v_cvt_pk_bf16_f32 v48, v33, v33
    v_cvt_pk_bf16_f32 v49, v33, v34
    v_cvt_pk_bf16_f32 v50, v34, v34
    v_cvt_pk_bf16_f32 v51, v35, v35
    v_mov_b32 v52, v48
    v_mov_b32 v53, v48
    v_mov_b32 v54, v50
    v_cvt_pk_bf16_f32 v55, v34, v35
    s_branch side_exp_join
side_exp_h1:
    ds_read_b32 v24, v236 offset:1408
    ds_read_b32 v40, v236 offset:16256
    ds_read_b32 v25, v236 offset:1412
    ds_read_b32 v41, v236 offset:16260
    ds_read_b32 v26, v236 offset:1664
    ds_read_b32 v42, v236 offset:16512
    ds_read_b32 v27, v236 offset:1668
    ds_read_b32 v43, v236 offset:16516
    v_and_b32 v11, 1, v0
    v_cmp_eq_u32 vcc, 0, v11
    s_waitcnt lgkmcnt(0)
    v_add_f32 v24, v24, v40
    v_add_f32 v25, v25, v41
    v_add_f32 v26, v26, v42
    v_add_f32 v27, v27, v43
    v_cndmask_b32 v12, v25, v24, vcc
    v_cvt_pk_bf16_f32 v40, v24, v24
    v_cvt_pk_bf16_f32 v43, v25, v25
    v_cvt_pk_bf16_f32 v42, v12, v25
    v_cvt_pk_bf16_f32 v46, v24, v12
    v_mov_b32 v41, v40
    v_mov_b32 v44, v40
    v_mov_b32 v45, v40
    v_mov_b32 v47, v43
    v_cndmask_b32 v12, v27, v26, vcc
    v_cvt_pk_bf16_f32 v48, v26, v26
    v_cvt_pk_bf16_f32 v51, v27, v27
    v_cvt_pk_bf16_f32 v50, v12, v27
    v_cvt_pk_bf16_f32 v54, v26, v12
    v_mov_b32 v49, v48
    v_mov_b32 v52, v48
    v_mov_b32 v53, v48
    v_mov_b32 v55, v51
side_exp_join:
    s_barrier
    s_cmp_eq_u32 s6, 0
    s_cbranch_scc0 side_nozero
    v_lshrrev_b32 v10, 3, v0
    v_and_b32 v11, 7, v0
    v_mul_u32_u24 v10, 4160, v10
    v_lshlrev_b32 v12, 4, v11
    v_add_u32 v10, v10, v12
    v_add_u32 v10, s50, v10
    v_mov_b32 v56, 0
    v_mov_b32 v57, 0
    v_mov_b32 v58, 0
    v_mov_b32 v59, 0
    v_cmp_gt_u32 vcc, 5, v11
    v_cmp_gt_u32 s[40:41], 32, v0
    s_and_b64 vcc, vcc, s[40:41]
    s_and_saveexec_b64 s[40:41], vcc
    ds_write_b128 v10, v[56:59]
    s_mov_b64 exec, s[40:41]
side_nozero:
    ds_write_b128 v237, v[40:43] offset:0
    ds_write_b128 v237, v[44:47] offset:4160
    ds_write_b128 v237, v[48:51] offset:1024
    ds_write_b128 v237, v[52:55] offset:5184
    v_add_u32 v11, 8324, v237
    v_add_u32 v12, 12484, v237
    ds_write2_b32 v11, v40, v41 offset0:0 offset1:1
    ds_write2_b32 v11, v42, v43 offset0:2 offset1:3
    ds_write2_b32 v12, v44, v45 offset0:0 offset1:1
    ds_write2_b32 v12, v46, v47 offset0:2 offset1:3
    v_add_u32 v11, 1024, v11
    v_add_u32 v12, 1024, v12
    ds_write2_b32 v11, v48, v49 offset0:0 offset1:1
    ds_write2_b32 v11, v50, v51 offset0:2 offset1:3
    ds_write2_b32 v12, v52, v53 offset0:0 offset1:1
    ds_write2_b32 v12, v54, v55 offset0:2 offset1:3
    s_waitcnt vmcnt(0) lgkmcnt(0)
    s_barrier
    ds_read_b128 v[32:35], v239 offset:1200
    ds_read_b64_tr_b16 v[24:25], v238 offset:40
    ds_read_b64_tr_b16 v[26:27], v238 offset:32
    ds_read_b128 v[36:39], v239 offset:3760
    ds_read_b64_tr_b16 v[28:29], v238 offset:2088
    ds_read_b64_tr_b16 v[30:31], v238 offset:2080
    ds_read_b128 v[48:51], v239 offset:1232
    ds_read_b64_tr_b16 v[40:41], v238 offset:8
    ds_read_b64_tr_b16 v[42:43], v238 offset:0
    ds_read_b128 v[52:55], v239 offset:3792
    ds_read_b64_tr_b16 v[44:45], v238 offset:2056
    ds_read_b64_tr_b16 v[46:47], v238 offset:2048
    s_waitcnt lgkmcnt(6)
    v_mfma_f32_32x32x16_bf16 v[96:111], v[24:27], v[32:35], 0
    ds_read_b128 v[64:67], v239 offset:1120
    ds_read_b64_tr_b16 v[56:57], v238 offset:104
    v_mfma_f32_32x32x16_bf16 v[112:127], v[24:27], v[36:39], 0
    ds_read_b64_tr_b16 v[58:59], v238 offset:96
    ds_read_b128 v[68:71], v239 offset:3680
    v_mfma_f32_32x32x16_bf16 v[112:127], v[28:31], v[32:35], v[112:127]
    ds_read_b64_tr_b16 v[60:61], v238 offset:2152
    ds_read_b64_tr_b16 v[62:63], v238 offset:2144
    s_waitcnt lgkmcnt(6)
    v_mfma_f32_32x32x16_bf16 v[96:111], v[40:43], v[48:51], v[96:111]
    ds_read_b128 v[32:35], v239 offset:1152
    ds_read_b64_tr_b16 v[24:25], v238 offset:72
    v_mfma_f32_32x32x16_bf16 v[112:127], v[40:43], v[52:55], v[112:127]
    ds_read_b64_tr_b16 v[26:27], v238 offset:64
    ds_read_b128 v[36:39], v239 offset:3712
    v_mfma_f32_32x32x16_bf16 v[112:127], v[44:47], v[48:51], v[112:127]
    ds_read_b64_tr_b16 v[28:29], v238 offset:2120
    ds_read_b64_tr_b16 v[30:31], v238 offset:2112
    s_waitcnt lgkmcnt(6)
    v_mfma_f32_32x32x16_bf16 v[96:111], v[56:59], v[64:67], v[96:111]
    ds_read_b128 v[48:51], v239 offset:1040
    ds_read_b64_tr_b16 v[40:41], v238 offset:168
    v_mfma_f32_32x32x16_bf16 v[112:127], v[56:59], v[68:71], v[112:127]
    ds_read_b64_tr_b16 v[42:43], v238 offset:160
    ds_read_b128 v[52:55], v239 offset:3600
    v_mfma_f32_32x32x16_bf16 v[112:127], v[60:63], v[64:67], v[112:127]
    ds_read_b64_tr_b16 v[44:45], v238 offset:2216
    ds_read_b64_tr_b16 v[46:47], v238 offset:2208
    s_waitcnt lgkmcnt(6)
    v_mfma_f32_32x32x16_bf16 v[96:111], v[24:27], v[32:35], v[96:111]
    ds_read_b128 v[64:67], v239 offset:1072
    ds_read_b64_tr_b16 v[56:57], v238 offset:136
    v_mfma_f32_32x32x16_bf16 v[112:127], v[24:27], v[36:39], v[112:127]
    ds_read_b64_tr_b16 v[58:59], v238 offset:128
    ds_read_b128 v[68:71], v239 offset:3632
    v_mfma_f32_32x32x16_bf16 v[112:127], v[28:31], v[32:35], v[112:127]
    ds_read_b64_tr_b16 v[60:61], v238 offset:2184
    ds_read_b64_tr_b16 v[62:63], v238 offset:2176
    s_waitcnt lgkmcnt(6)
    v_mfma_f32_32x32x16_bf16 v[96:111], v[40:43], v[48:51], v[96:111]
    ds_read_b128 v[32:35], v239 offset:960
    ds_read_b64_tr_b16 v[24:25], v238 offset:232
    v_mfma_f32_32x32x16_bf16 v[112:127], v[40:43], v[52:55], v[112:127]
    ds_read_b64_tr_b16 v[26:27], v238 offset:224
    ds_read_b128 v[36:39], v239 offset:3520
    v_mfma_f32_32x32x16_bf16 v[112:127], v[44:47], v[48:51], v[112:127]
    ds_read_b64_tr_b16 v[28:29], v238 offset:2280
    ds_read_b64_tr_b16 v[30:31], v238 offset:2272
    s_waitcnt lgkmcnt(6)
    v_mfma_f32_32x32x16_bf16 v[96:111], v[56:59], v[64:67], v[96:111]
    ds_read_b128 v[48:51], v239 offset:992
    ds_read_b64_tr_b16 v[40:41], v238 offset:200
    v_mfma_f32_32x32x16_bf16 v[112:127], v[56:59], v[68:71], v[112:127]
    ds_read_b64_tr_b16 v[42:43], v238 offset:192
    ds_read_b128 v[52:55], v239 offset:3552
    v_mfma_f32_32x32x16_bf16 v[112:127], v[60:63], v[64:67], v[112:127]
    ds_read_b64_tr_b16 v[44:45], v238 offset:2248
    ds_read_b64_tr_b16 v[46:47], v238 offset:2240
    s_waitcnt lgkmcnt(6)
    v_mfma_f32_32x32x16_bf16 v[96:111], v[24:27], v[32:35], v[96:111]
    ds_read_b128 v[64:67], v239 offset:880
    ds_read_b64_tr_b16 v[56:57], v238 offset:296
    v_mfma_f32_32x32x16_bf16 v[112:127], v[24:27], v[36:39], v[112:127]
    ds_read_b64_tr_b16 v[58:59], v238 offset:288
    ds_read_b128 v[68:71], v239 offset:3440
    v_mfma_f32_32x32x16_bf16 v[112:127], v[28:31], v[32:35], v[112:127]
    ds_read_b64_tr_b16 v[60:61], v238 offset:2344
    ds_read_b64_tr_b16 v[62:63], v238 offset:2336
    s_waitcnt lgkmcnt(6)
    v_mfma_f32_32x32x16_bf16 v[96:111], v[40:43], v[48:51], v[96:111]
    ds_read_b128 v[32:35], v239 offset:912
    ds_read_b64_tr_b16 v[24:25], v238 offset:264
    v_mfma_f32_32x32x16_bf16 v[112:127], v[40:43], v[52:55], v[112:127]
    ds_read_b64_tr_b16 v[26:27], v238 offset:256
    ds_read_b128 v[36:39], v239 offset:3472
    v_mfma_f32_32x32x16_bf16 v[112:127], v[44:47], v[48:51], v[112:127]
    ds_read_b64_tr_b16 v[28:29], v238 offset:2312
    ds_read_b64_tr_b16 v[30:31], v238 offset:2304
    s_waitcnt lgkmcnt(6)
    v_mfma_f32_32x32x16_bf16 v[96:111], v[56:59], v[64:67], v[96:111]
    ds_read_b128 v[48:51], v239 offset:800
    ds_read_b64_tr_b16 v[40:41], v238 offset:360
    v_mfma_f32_32x32x16_bf16 v[112:127], v[56:59], v[68:71], v[112:127]
    ds_read_b64_tr_b16 v[42:43], v238 offset:352
    ds_read_b128 v[52:55], v239 offset:3360
    v_mfma_f32_32x32x16_bf16 v[112:127], v[60:63], v[64:67], v[112:127]
    ds_read_b64_tr_b16 v[44:45], v238 offset:2408
    ds_read_b64_tr_b16 v[46:47], v238 offset:2400
    s_waitcnt lgkmcnt(6)
    v_mfma_f32_32x32x16_bf16 v[96:111], v[24:27], v[32:35], v[96:111]
    ds_read_b128 v[64:67], v239 offset:832
    ds_read_b64_tr_b16 v[56:57], v238 offset:328
    v_mfma_f32_32x32x16_bf16 v[112:127], v[24:27], v[36:39], v[112:127]
    ds_read_b64_tr_b16 v[58:59], v238 offset:320
    ds_read_b128 v[68:71], v239 offset:3392
    v_mfma_f32_32x32x16_bf16 v[112:127], v[28:31], v[32:35], v[112:127]
    ds_read_b64_tr_b16 v[60:61], v238 offset:2376
    ds_read_b64_tr_b16 v[62:63], v238 offset:2368
    s_waitcnt lgkmcnt(6)
    v_mfma_f32_32x32x16_bf16 v[96:111], v[40:43], v[48:51], v[96:111]
    ds_read_b128 v[32:35], v239 offset:720
    ds_read_b64_tr_b16 v[24:25], v238 offset:424
    v_mfma_f32_32x32x16_bf16 v[112:127], v[40:43], v[52:55], v[112:127]
    ds_read_b64_tr_b16 v[26:27], v238 offset:416
    ds_read_b128 v[36:39], v239 offset:3280
    v_mfma_f32_32x32x16_bf16 v[112:127], v[44:47], v[48:51], v[112:127]
    ds_read_b64_tr_b16 v[28:29], v238 offset:2472
    ds_read_b64_tr_b16 v[30:31], v238 offset:2464
    s_waitcnt lgkmcnt(6)
    v_mfma_f32_32x32x16_bf16 v[96:111], v[56:59], v[64:67], v[96:111]
    ds_read_b128 v[48:51], v239 offset:752
    ds_read_b64_tr_b16 v[40:41], v238 offset:392
    v_mfma_f32_32x32x16_bf16 v[112:127], v[56:59], v[68:71], v[112:127]
    ds_read_b64_tr_b16 v[42:43], v238 offset:384
    ds_read_b128 v[52:55], v239 offset:3312
    v_mfma_f32_32x32x16_bf16 v[112:127], v[60:63], v[64:67], v[112:127]
    ds_read_b64_tr_b16 v[44:45], v238 offset:2440
    ds_read_b64_tr_b16 v[46:47], v238 offset:2432
    s_waitcnt lgkmcnt(6)
    v_mfma_f32_32x32x16_bf16 v[96:111], v[24:27], v[32:35], v[96:111]
    ds_read_b128 v[64:67], v239 offset:640
    ds_read_b64_tr_b16 v[56:57], v238 offset:488
    v_mfma_f32_32x32x16_bf16 v[112:127], v[24:27], v[36:39], v[112:127]
    ds_read_b64_tr_b16 v[58:59], v238 offset:480
    ds_read_b128 v[68:71], v239 offset:3200
    v_mfma_f32_32x32x16_bf16 v[112:127], v[28:31], v[32:35], v[112:127]
    ds_read_b64_tr_b16 v[60:61], v238 offset:2536
    ds_read_b64_tr_b16 v[62:63], v238 offset:2528
    s_waitcnt lgkmcnt(6)
    v_mfma_f32_32x32x16_bf16 v[96:111], v[40:43], v[48:51], v[96:111]
    ds_read_b128 v[32:35], v239 offset:672
    ds_read_b64_tr_b16 v[24:25], v238 offset:456
    v_mfma_f32_32x32x16_bf16 v[112:127], v[40:43], v[52:55], v[112:127]
    ds_read_b64_tr_b16 v[26:27], v238 offset:448
    ds_read_b128 v[36:39], v239 offset:3232
    v_mfma_f32_32x32x16_bf16 v[112:127], v[44:47], v[48:51], v[112:127]
    ds_read_b64_tr_b16 v[28:29], v238 offset:2504
    ds_read_b64_tr_b16 v[30:31], v238 offset:2496
    s_waitcnt lgkmcnt(6)
    v_mfma_f32_32x32x16_bf16 v[96:111], v[56:59], v[64:67], v[96:111]
    ds_read_b128 v[48:51], v239 offset:560
    ds_read_b64_tr_b16 v[40:41], v238 offset:552
    v_mfma_f32_32x32x16_bf16 v[112:127], v[56:59], v[68:71], v[112:127]
    ds_read_b64_tr_b16 v[42:43], v238 offset:544
    ds_read_b128 v[52:55], v239 offset:3120
    v_mfma_f32_32x32x16_bf16 v[112:127], v[60:63], v[64:67], v[112:127]
    ds_read_b64_tr_b16 v[44:45], v238 offset:2600
    ds_read_b64_tr_b16 v[46:47], v238 offset:2592
    s_waitcnt lgkmcnt(6)
    v_mfma_f32_32x32x16_bf16 v[96:111], v[24:27], v[32:35], v[96:111]
    ds_read_b128 v[64:67], v239 offset:592
    ds_read_b64_tr_b16 v[56:57], v238 offset:520
    v_mfma_f32_32x32x16_bf16 v[112:127], v[24:27], v[36:39], v[112:127]
    ds_read_b64_tr_b16 v[58:59], v238 offset:512
    ds_read_b128 v[68:71], v239 offset:3152
    v_mfma_f32_32x32x16_bf16 v[112:127], v[28:31], v[32:35], v[112:127]
    ds_read_b64_tr_b16 v[60:61], v238 offset:2568
    ds_read_b64_tr_b16 v[62:63], v238 offset:2560
    s_waitcnt lgkmcnt(6)
    v_mfma_f32_32x32x16_bf16 v[96:111], v[40:43], v[48:51], v[96:111]
    ds_read_b128 v[32:35], v239 offset:480
    ds_read_b64_tr_b16 v[24:25], v238 offset:616
    v_mfma_f32_32x32x16_bf16 v[112:127], v[40:43], v[52:55], v[112:127]
    ds_read_b64_tr_b16 v[26:27], v238 offset:608
    ds_read_b128 v[36:39], v239 offset:3040
    v_mfma_f32_32x32x16_bf16 v[112:127], v[44:47], v[48:51], v[112:127]
    ds_read_b64_tr_b16 v[28:29], v238 offset:2664
    ds_read_b64_tr_b16 v[30:31], v238 offset:2656
    s_waitcnt lgkmcnt(6)
    v_mfma_f32_32x32x16_bf16 v[96:111], v[56:59], v[64:67], v[96:111]
    ds_read_b128 v[48:51], v239 offset:512
    ds_read_b64_tr_b16 v[40:41], v238 offset:584
    v_mfma_f32_32x32x16_bf16 v[112:127], v[56:59], v[68:71], v[112:127]
    ds_read_b64_tr_b16 v[42:43], v238 offset:576
    ds_read_b128 v[52:55], v239 offset:3072
    v_mfma_f32_32x32x16_bf16 v[112:127], v[60:63], v[64:67], v[112:127]
    ds_read_b64_tr_b16 v[44:45], v238 offset:2632
    ds_read_b64_tr_b16 v[46:47], v238 offset:2624
    s_waitcnt lgkmcnt(6)
    v_mfma_f32_32x32x16_bf16 v[96:111], v[24:27], v[32:35], v[96:111]
    ds_read_b128 v[64:67], v239 offset:400
    ds_read_b64_tr_b16 v[56:57], v238 offset:680
    v_mfma_f32_32x32x16_bf16 v[112:127], v[24:27], v[36:39], v[112:127]
    ds_read_b64_tr_b16 v[58:59], v238 offset:672
    ds_read_b128 v[68:71], v239 offset:2960
    v_mfma_f32_32x32x16_bf16 v[112:127], v[28:31], v[32:35], v[112:127]
    ds_read_b64_tr_b16 v[60:61], v238 offset:2728
    ds_read_b64_tr_b16 v[62:63], v238 offset:2720
    s_waitcnt lgkmcnt(6)
    v_mfma_f32_32x32x16_bf16 v[96:111], v[40:43], v[48:51], v[96:111]
    ds_read_b128 v[32:35], v239 offset:432
    ds_read_b64_tr_b16 v[24:25], v238 offset:648
    v_mfma_f32_32x32x16_bf16 v[112:127], v[40:43], v[52:55], v[112:127]
    ds_read_b64_tr_b16 v[26:27], v238 offset:640
    ds_read_b128 v[36:39], v239 offset:2992
    v_mfma_f32_32x32x16_bf16 v[112:127], v[44:47], v[48:51], v[112:127]
    ds_read_b64_tr_b16 v[28:29], v238 offset:2696
    ds_read_b64_tr_b16 v[30:31], v238 offset:2688
    s_waitcnt lgkmcnt(6)
    v_mfma_f32_32x32x16_bf16 v[96:111], v[56:59], v[64:67], v[96:111]
    ds_read_b128 v[48:51], v239 offset:320
    ds_read_b64_tr_b16 v[40:41], v238 offset:744
    v_mfma_f32_32x32x16_bf16 v[112:127], v[56:59], v[68:71], v[112:127]
    ds_read_b64_tr_b16 v[42:43], v238 offset:736
    ds_read_b128 v[52:55], v239 offset:2880
    v_mfma_f32_32x32x16_bf16 v[112:127], v[60:63], v[64:67], v[112:127]
    ds_read_b64_tr_b16 v[44:45], v238 offset:2792
    ds_read_b64_tr_b16 v[46:47], v238 offset:2784
    s_waitcnt lgkmcnt(6)
    v_mfma_f32_32x32x16_bf16 v[96:111], v[24:27], v[32:35], v[96:111]
    ds_read_b128 v[64:67], v239 offset:352
    ds_read_b64_tr_b16 v[56:57], v238 offset:712
    v_mfma_f32_32x32x16_bf16 v[112:127], v[24:27], v[36:39], v[112:127]
    ds_read_b64_tr_b16 v[58:59], v238 offset:704
    ds_read_b128 v[68:71], v239 offset:2912
    v_mfma_f32_32x32x16_bf16 v[112:127], v[28:31], v[32:35], v[112:127]
    ds_read_b64_tr_b16 v[60:61], v238 offset:2760
    ds_read_b64_tr_b16 v[62:63], v238 offset:2752
    s_waitcnt lgkmcnt(6)
    v_mfma_f32_32x32x16_bf16 v[96:111], v[40:43], v[48:51], v[96:111]
    ds_read_b128 v[32:35], v239 offset:240
    ds_read_b64_tr_b16 v[24:25], v238 offset:808
    v_mfma_f32_32x32x16_bf16 v[112:127], v[40:43], v[52:55], v[112:127]
    ds_read_b64_tr_b16 v[26:27], v238 offset:800
    ds_read_b128 v[36:39], v239 offset:2800
    v_mfma_f32_32x32x16_bf16 v[112:127], v[44:47], v[48:51], v[112:127]
    ds_read_b64_tr_b16 v[28:29], v238 offset:2856
    ds_read_b64_tr_b16 v[30:31], v238 offset:2848
    s_waitcnt lgkmcnt(6)
    v_mfma_f32_32x32x16_bf16 v[96:111], v[56:59], v[64:67], v[96:111]
    ds_read_b128 v[48:51], v239 offset:272
    ds_read_b64_tr_b16 v[40:41], v238 offset:776
    v_mfma_f32_32x32x16_bf16 v[112:127], v[56:59], v[68:71], v[112:127]
    ds_read_b64_tr_b16 v[42:43], v238 offset:768
    ds_read_b128 v[52:55], v239 offset:2832
    v_mfma_f32_32x32x16_bf16 v[112:127], v[60:63], v[64:67], v[112:127]
    ds_read_b64_tr_b16 v[44:45], v238 offset:2824
    ds_read_b64_tr_b16 v[46:47], v238 offset:2816
    s_waitcnt lgkmcnt(6)
    v_mfma_f32_32x32x16_bf16 v[96:111], v[24:27], v[32:35], v[96:111]
    ds_read_b128 v[64:67], v239 offset:160
    ds_read_b64_tr_b16 v[56:57], v238 offset:872
    v_mfma_f32_32x32x16_bf16 v[112:127], v[24:27], v[36:39], v[112:127]
    ds_read_b64_tr_b16 v[58:59], v238 offset:864
    ds_read_b128 v[68:71], v239 offset:2720
    v_mfma_f32_32x32x16_bf16 v[112:127], v[28:31], v[32:35], v[112:127]
    ds_read_b64_tr_b16 v[60:61], v238 offset:2920
    ds_read_b64_tr_b16 v[62:63], v238 offset:2912
    s_waitcnt lgkmcnt(6)
    v_mfma_f32_32x32x16_bf16 v[96:111], v[40:43], v[48:51], v[96:111]
    ds_read_b128 v[32:35], v239 offset:192
    ds_read_b64_tr_b16 v[24:25], v238 offset:840
    v_mfma_f32_32x32x16_bf16 v[112:127], v[40:43], v[52:55], v[112:127]
    ds_read_b64_tr_b16 v[26:27], v238 offset:832
    ds_read_b128 v[36:39], v239 offset:2752
    v_mfma_f32_32x32x16_bf16 v[112:127], v[44:47], v[48:51], v[112:127]
    ds_read_b64_tr_b16 v[28:29], v238 offset:2888
    ds_read_b64_tr_b16 v[30:31], v238 offset:2880
    s_waitcnt lgkmcnt(6)
    v_mfma_f32_32x32x16_bf16 v[96:111], v[56:59], v[64:67], v[96:111]
    ds_read_b128 v[48:51], v239 offset:80
    ds_read_b64_tr_b16 v[40:41], v238 offset:936
    v_mfma_f32_32x32x16_bf16 v[112:127], v[56:59], v[68:71], v[112:127]
    ds_read_b64_tr_b16 v[42:43], v238 offset:928
    ds_read_b128 v[52:55], v239 offset:2640
    v_mfma_f32_32x32x16_bf16 v[112:127], v[60:63], v[64:67], v[112:127]
    ds_read_b64_tr_b16 v[44:45], v238 offset:2984
    ds_read_b64_tr_b16 v[46:47], v238 offset:2976
    s_waitcnt lgkmcnt(6)
    v_mfma_f32_32x32x16_bf16 v[96:111], v[24:27], v[32:35], v[96:111]
    ds_read_b128 v[64:67], v239 offset:112
    ds_read_b64_tr_b16 v[56:57], v238 offset:904
    v_mfma_f32_32x32x16_bf16 v[112:127], v[24:27], v[36:39], v[112:127]
    ds_read_b64_tr_b16 v[58:59], v238 offset:896
    ds_read_b128 v[68:71], v239 offset:2672
    v_mfma_f32_32x32x16_bf16 v[112:127], v[28:31], v[32:35], v[112:127]
    ds_read_b64_tr_b16 v[60:61], v238 offset:2952
    ds_read_b64_tr_b16 v[62:63], v238 offset:2944
    s_waitcnt lgkmcnt(6)
    v_mfma_f32_32x32x16_bf16 v[96:111], v[40:43], v[48:51], v[96:111]
    ds_read_b128 v[32:35], v239 offset:0
    ds_read_b64_tr_b16 v[24:25], v238 offset:1000
    v_mfma_f32_32x32x16_bf16 v[112:127], v[40:43], v[52:55], v[112:127]
    ds_read_b64_tr_b16 v[26:27], v238 offset:992
    ds_read_b128 v[36:39], v239 offset:2560
    v_mfma_f32_32x32x16_bf16 v[112:127], v[44:47], v[48:51], v[112:127]
    ds_read_b64_tr_b16 v[28:29], v238 offset:3048
    ds_read_b64_tr_b16 v[30:31], v238 offset:3040
    s_waitcnt lgkmcnt(6)
    v_mfma_f32_32x32x16_bf16 v[96:111], v[56:59], v[64:67], v[96:111]
    ds_read_b128 v[48:51], v239 offset:32
    ds_read_b64_tr_b16 v[40:41], v238 offset:968
    v_mfma_f32_32x32x16_bf16 v[112:127], v[56:59], v[68:71], v[112:127]
    ds_read_b64_tr_b16 v[42:43], v238 offset:960
    ds_read_b128 v[52:55], v239 offset:2592
    v_mfma_f32_32x32x16_bf16 v[112:127], v[60:63], v[64:67], v[112:127]
    ds_read_b64_tr_b16 v[44:45], v238 offset:3016
    ds_read_b64_tr_b16 v[46:47], v238 offset:3008
    s_waitcnt lgkmcnt(6)
    v_mfma_f32_32x32x16_bf16 v[96:111], v[24:27], v[32:35], v[96:111]
    v_mfma_f32_32x32x16_bf16 v[112:127], v[24:27], v[36:39], v[112:127]
    v_mfma_f32_32x32x16_bf16 v[112:127], v[28:31], v[32:35], v[112:127]
    s_waitcnt lgkmcnt(0)
    v_mfma_f32_32x32x16_bf16 v[96:111], v[40:43], v[48:51], v[96:111]
    v_mfma_f32_32x32x16_bf16 v[112:127], v[40:43], v[52:55], v[112:127]
    v_mfma_f32_32x32x16_bf16 v[112:127], v[44:47], v[48:51], v[112:127]
    s_nop 15
    s_barrier
    s_cmp_eq_u32 s6, 0
    s_cbranch_scc0 side_x_h1
    ds_write_b128 v240, v[112:115] offset:0
    ds_write_b128 v240, v[116:119] offset:1024
    ds_write_b128 v240, v[120:123] offset:2048
    ds_write_b128 v240, v[124:127] offset:3072
    s_branch side_x_j
side_x_h1:
    ds_write_b128 v240, v[96:99] offset:0
    ds_write_b128 v240, v[100:103] offset:1024
    ds_write_b128 v240, v[104:107] offset:2048
    ds_write_b128 v240, v[108:111] offset:3072
    v_mov_b32 v96, v112
    v_mov_b32 v97, v113
    v_mov_b32 v98, v114
    v_mov_b32 v99, v115
    v_mov_b32 v100, v116
    v_mov_b32 v101, v117
    v_mov_b32 v102, v118
    v_mov_b32 v103, v119
    v_mov_b32 v104, v120
    v_mov_b32 v105, v121
    v_mov_b32 v106, v122
    v_mov_b32 v107, v123
    v_mov_b32 v108, v124
    v_mov_b32 v109, v125
    v_mov_b32 v110, v126
    v_mov_b32 v111, v127
side_x_j:
    s_mov_b32 s54, 0xffff0000
    s_lshl_b32 s24, s5, 12
    s_lshl_b32 s25, s6, 11
    s_add_u32 s24, s24, s25
    s_waitcnt lgkmcnt(0)
    s_barrier
    ds_read_b128 v[24:27], v241 offset:0
    ds_read_b128 v[28:31], v241 offset:1024
    ds_read_b128 v[32:35], v241 offset:2048
    ds_read_b128 v[36:39], v241 offset:3072
    ds_read_b128 v[40:43], v242 offset:0
    ds_read_b128 v[44:47], v242 offset:32
    s_waitcnt lgkmcnt(2)
    v_add_f32 v24, v24, v96
    v_add_f32 v25, v25, v97
    v_add_f32 v26, v26, v98
    v_add_f32 v27, v27, v99
    v_add_f32 v28, v28, v100
    v_add_f32 v29, v29, v101
    v_add_f32 v30, v30, v102
    v_add_f32 v31, v31, v103
    v_add_f32 v32, v32, v104
    v_add_f32 v33, v33, v105
    v_add_f32 v34, v34, v106
    v_add_f32 v35, v35, v107
    v_add_f32 v36, v36, v108
    v_add_f32 v37, v37, v109
    v_add_f32 v38, v38, v110
    v_add_f32 v39, v39, v111
    s_waitcnt lgkmcnt(0)
    v_lshlrev_b32 v65, 16, v40
    v_and_b32 v66, s54, v40
    v_fmac_f32 v24, s51, v65
    v_fmac_f32 v25, s51, v66
    v_cvt_pk_bf16_f32 v72, v24, v25
    v_lshlrev_b32 v65, 16, v41
    v_and_b32 v66, s54, v41
    v_fmac_f32 v26, s51, v65
    v_fmac_f32 v27, s51, v66
    v_cvt_pk_bf16_f32 v73, v26, v27
    v_lshlrev_b32 v65, 16, v42
    v_and_b32 v66, s54, v42
    v_fmac_f32 v28, s51, v65
    v_fmac_f32 v29, s51, v66
    v_cvt_pk_bf16_f32 v74, v28, v29
    v_lshlrev_b32 v65, 16, v43
    v_and_b32 v66, s54, v43
    v_fmac_f32 v30, s51, v65
    v_fmac_f32 v31, s51, v66
    v_cvt_pk_bf16_f32 v75, v30, v31
    ds_write_b128 v243, v[72:75] offset:0
    v_lshlrev_b32 v65, 16, v44
    v_and_b32 v66, s54, v44
    v_fmac_f32 v32, s51, v65
    v_fmac_f32 v33, s51, v66
    v_cvt_pk_bf16_f32 v76, v32, v33
    v_lshlrev_b32 v65, 16, v45
    v_and_b32 v66, s54, v45
    v_fmac_f32 v34, s51, v65
    v_fmac_f32 v35, s51, v66
    v_cvt_pk_bf16_f32 v77, v34, v35
    v_lshlrev_b32 v65, 16, v46
    v_and_b32 v66, s54, v46
    v_fmac_f32 v36, s51, v65
    v_fmac_f32 v37, s51, v66
    v_cvt_pk_bf16_f32 v78, v36, v37
    v_lshlrev_b32 v65, 16, v47
    v_and_b32 v66, s54, v47
    v_fmac_f32 v38, s51, v65
    v_fmac_f32 v39, s51, v66
    v_cvt_pk_bf16_f32 v79, v38, v39
    ds_write_b128 v243, v[76:79] offset:32
    v_lshlrev_b32 v10, 4, v0
    v_add_u32 v11, s56, v10
    ds_read_b128 v[24:27], v11 offset:0
    ds_read_b128 v[28:31], v11 offset:1024
    s_waitcnt lgkmcnt(1)
    buffer_store_dwordx4 v[24:27], v10, s[16:19], s24 offen offset:0 sc1
    s_waitcnt lgkmcnt(0)
    buffer_store_dwordx4 v[28:31], v10, s[16:19], s24 offen offset:1024 sc1
    s_waitcnt vmcnt(0)
    s_barrier
    s_cmp_lg_u32 s4, 0
    s_cbranch_scc1 side_done
    s_lshr_b32 s24, s3, 5
    s_add_u32 s24, s24, 224
    s_lshl_b32 s24, s24, 7
    s_and_b32 s25, s3, 31
    s_lshl_b32 s25, s25, 2
    s_add_u32 s24, s24, s25
    v_mul_u32_u24 v10, 896, v0
    v_mov_b32 v11, s53
    s_mov_b64 exec, 0xffffffff
    buffer_store_dword v11, v10, s[20:23], s24 offen sc1
    s_mov_b64 exec, -1
side_done:
f_exit:
    s_endpgm
f_code_end:
.section .rodata,"a"
.p2align 6
.amdhsa_kernel gated_mix__ssm_conv_s4__glu_gated_bilinear__prompt_kernel
  .amdhsa_next_free_vgpr 256
  .amdhsa_next_free_sgpr 102
  .amdhsa_accum_offset 256
  .amdhsa_group_segment_fixed_size 0
  .amdhsa_kernarg_size 136
  .amdhsa_user_sgpr_count 2
  .amdhsa_user_sgpr_kernarg_segment_ptr 1
  .amdhsa_system_sgpr_workgroup_id_x 1
  .amdhsa_float_denorm_mode_32 3
.end_amdhsa_kernel
.text
```
